```python
import torch

def _softmax(x, axis=-1):
    return torch.softmax(x, dim=axis)
def _gelu(x):
    return torch.nn.functional.gelu(x, approximate="tanh")
def _silu(x):
    return torch.nn.functional.silu(x)
def _sigmoid(x):
    return torch.sigmoid(x)
def _layernorm(x, axis=-1, eps=1e-5):
    m = x.mean(dim=axis, keepdim=True)
    v = x.var(dim=axis, keepdim=True, unbiased=False)
    return (x - m) / torch.sqrt(v + eps)
def _scatter_add(tgt, idx, src, axis=0):
    return tgt.clone().index_add_(axis, idx, src)
def _segment_sum(src, seg, n):
    out = torch.zeros((n,) + src.shape[1:], dtype=src.dtype)
    return out.index_add_(0, seg, src)
def _pad(x, pw):
    flat = tuple(v for pair in reversed(pw) for v in pair)
    return torch.nn.functional.pad(x, flat)

kernel_name = 'sequential_preLN__linear_kernel_hedgehog__geglu_ffn__prompt'

def setup_inputs():

    _w = (lambda a: (lambda t: t.to(torch.bfloat16) if t.is_floating_point() else t)(torch.as_tensor(a)))
    def _A_setup():
        B, S, D, H = 1, 2048, 640, 32
        Dh = D // H
        return {
            "x": _w((lambda *s: torch.randn(*s, dtype=torch.bfloat16) * 0.05)(B, S, D)),
            "wqkv": _w((lambda *s: torch.randn(*s, dtype=torch.bfloat16) * 0.2)(D, 3 * D)),
            "w_phi": _w((lambda *s: torch.randn(*s, dtype=torch.bfloat16) * 0.2)(H, Dh, Dh) * (Dh ** -0.5)),
            "wo": _w((lambda *s: torch.randn(*s, dtype=torch.bfloat16) * 0.05)(D, D)),
        }
    _A_in = _A_setup()

    def _B_setup():
        B, S, D, F = 1, 2048, 640, 1536
        return {
            "x": _w((lambda *s: torch.randn(*s, dtype=torch.bfloat16) * 0.05)(B, S, D)),
            "w_gate": _w((lambda *s: torch.randn(*s, dtype=torch.bfloat16) * 0.05)(D, F)),
            "w_up": _w((lambda *s: torch.randn(*s, dtype=torch.bfloat16) * 0.05)(D, F)),
            "w_down": _w((lambda *s: torch.randn(*s, dtype=torch.bfloat16) * 0.05)(F, D)),
        }
    _B_in = _B_setup()

    return {
        "A_x": _A_in["x"],
        "A_wqkv": _A_in["wqkv"],
        "A_w_phi": _A_in["w_phi"],
        "A_wo": _A_in["wo"],
        "B_x": _B_in["x"],
        "B_w_gate": _B_in["w_gate"],
        "B_w_up": _B_in["w_up"],
        "B_w_down": _B_in["w_down"],
    }

def reference(A_x, A_wqkv, A_w_phi, A_wo, B_x, B_w_gate, B_w_up, B_w_down):
    def _A_ref(x, wqkv, w_phi, wo):
        B, S, D = x.shape
        H = 32; Dh = D // H
        qkv = (lambda x, *d: x.permute(*d))((x @ wqkv).reshape(B, S, 3, H, Dh), 2, 0, 3, 1, 4)
        q, k, v = qkv[0], qkv[1], qkv[2]
        pq = torch.einsum("bhsd,hdf->bhsf", q, w_phi)
        pk = torch.einsum("bhsd,hdf->bhsf", k, w_phi)
        phi_q = torch.concatenate([_softmax(pq, axis=-1), _softmax(-pq, axis=-1)], axis=-1)
        phi_k = torch.concatenate([_softmax(pk, axis=-1), _softmax(-pk, axis=-1)], axis=-1)
        kv = torch.einsum("bhsf,bhsd->bhfd", phi_k, v)
        z  = torch.einsum("bhsf->bhf", phi_k)
        num = torch.einsum("bhqf,bhfd->bhqd", phi_q, kv)
        den = torch.einsum("bhqf,bhf->bhq", phi_q, z)[..., None] + 1e-6
        o = num / den
        return (lambda x, *d: x.permute(*d))(o, 0, 2, 1, 3).reshape(B, S, D) @ wo

    def _B_ref(x, w_gate, w_up, w_down):
        return (_gelu(x @ w_gate) * (x @ w_up)) @ w_down

    x = A_x
    h = x + _A_ref(_layernorm(x, axis=-1), A_wqkv, A_w_phi, A_wo)
    h2 = h + _B_ref(_layernorm(h, axis=-1), B_w_gate, B_w_up, B_w_down)
    return h2
```

```asm
; @launch kernel=sequential_preLN__linear_kernel_hedgehog__geglu_ffn__prompt_kernel grid=(256,1,1) block=(256,1,1) lds=163840
.amdgcn_target "amdgcn-amd-amdhsa--gfx950"
.text
.globl sequential_preLN__linear_kernel_hedgehog__geglu_ffn__prompt_kernel
.p2align 8
.type sequential_preLN__linear_kernel_hedgehog__geglu_ffn__prompt_kernel,@function
sequential_preLN__linear_kernel_hedgehog__geglu_ffn__prompt_kernel:
    s_cmp_ge_u32 s2, 256
    s_cbranch_scc1 L_end
    s_load_dwordx4 s[80:83], s[0:1], 0
    s_getpc_b64 s[60:61]
    s_load_dwordx4 s[84:87], s[0:1], 16
    s_load_dwordx8 s[88:95], s[0:1], 32
    s_load_dwordx4 s[96:99], s[0:1], 64
    s_load_dwordx2 s[100:101], s[0:1], 80
    s_and_b32 s60, s60, 0xffffff00
    s_mov_b32 s62, L_fin-sequential_preLN__linear_kernel_hedgehog__geglu_ffn__prompt_kernel+256
    s_mov_b32 s63, 0x20000
    s_lshr_b32 s64, s2, 3
    s_lshl_b32 s64, s64, 12
    v_lshlrev_b32 v2, 4, v0
    buffer_load_dwordx4 v[4:7], v2, s[60:63], s64 offen
    v_lshrrev_b32 v2, 6, v0
    v_and_b32 v1, 63, v0
    v_readfirstlane_b32 s3, v2
    s_and_b32 s36, s2, 7
    s_lshl_b32 s36, s36, 1
    s_lshr_b32 s49, s2, 7
    s_add_u32 s36, s36, s49
    s_bitcmp1_b32 s2, 0
    s_cselect_b32 s49, 0, 0
    s_bfe_u32 s50, s2, 0x40003
    s_mul_i32 s50, s50, 5
    s_add_u32 s49, s49, s50
    s_mul_i32 s50, s36, 1
    s_add_u32 s49, s49, s50
    s_mul_i32 s50, s49, 205
    s_lshr_b32 s50, s50, 11
    s_mul_i32 s50, s50, 10
    s_sub_u32 s49, s49, s50
    s_mul_i32 s42, s36, 163840
    s_lshl_b32 s50, s49, 7
    s_add_u32 s44, s42, s50
    s_lshl_b32 s46, s3, 12
    s_add_u32 s46, s46, 94208
    s_mov_b32 s6, 2621440
    s_mov_b32 s7, 0x20000
    v_lshrrev_b32 v3, 3, v1
    v_lshl_add_u32 v3, v2, 5, v3
    v_mul_u32_u24 v3, 1280, v3
    v_lshrrev_b32 v8, 4, v1
    v_and_b32 v9, 7, v1
    v_xor_b32 v9, v8, v9
    v_lshl_add_u32 v10, v9, 4, v3
    v_xor_b32_e64 v9, 4, v9
    v_lshl_add_u32 v11, v9, 4, v3
    v_add_u32 v11, 9216, v11
    v_add_u32 v12, 18432, v10
    v_add_u32 v13, 18432, v11
    s_waitcnt lgkmcnt(0)
    s_mov_b32 s4, s80
    s_mov_b32 s5, s81
    s_add_u32 m0, s46, 0
    s_nop 0
    buffer_load_dwordx4 v10, s[4:7], s44 offen offset:0 lds
    buffer_load_dwordx4 v11, s[4:7], s44 offen offset:1024 lds
    s_bfe_u32 s37, s2, 0x40003
    s_add_u32 s40, s42, 1280
    s_mul_i32 s43, s37, 80
    s_mul_i32 s49, s49, 245760
    s_add_u32 s45, s43, s49
    s_xor_b32 s50, s37, 1
    s_mul_i32 s74, s50, 80
    s_add_u32 s41, s74, s49
    s_mul_i32 s47, s3, 3072
    s_add_u32 s47, s47, 45056
    s_mov_b32 s8, s82
    s_mov_b32 s9, s83
    s_mov_b32 s10, 2457600
    s_mov_b32 s11, 0x20000
    buffer_load_dwordx4 v12, s[4:7], s44 offen offset:2048 lds
    v_add_u32 v3, 0, v1
    v_mul_u32_u24 v8, 171, v3
    v_lshrrev_b32 v8, 11, v8
    v_mul_u32_u24 v9, 12, v8
    v_sub_u32 v3, v3, v9
    v_lshl_add_u32 v8, v2, 4, v8
    v_mul_u32_u24 v8, 3840, v8
    v_min_u32_e64 v9, 9, v3
    v_lshl_add_u32 v8, v9, 4, v8
    v_add_u32 v9, 1280, v8
    v_add_u32 v8, 2480, v8
    v_cmp_gt_u32 vcc, 5, v3
    s_nop 1
    v_cndmask_b32 v14, v8, v9, vcc
    v_cmp_ne_u32 s[58:59], 10, v3
    buffer_load_dwordx4 v13, s[4:7], s44 offen offset:3072 lds
    v_add_u32 v3, 64, v1
    v_mul_u32_u24 v8, 171, v3
    v_lshrrev_b32 v8, 11, v8
    v_mul_u32_u24 v9, 12, v8
    v_sub_u32 v3, v3, v9
    v_lshl_add_u32 v8, v2, 4, v8
    v_mul_u32_u24 v8, 3840, v8
    v_min_u32 v9, 9, v3
    v_lshl_add_u32 v8, v9, 4, v8
    v_add_u32 v9, 256, v8
    v_add_u32 v8, 1456, v8
    v_cmp_gt_u32 vcc, 5, v3
    s_nop 1
    v_cndmask_b32 v15, v8, v9, vcc
    v_cmp_ne_u32 s[60:61], 10, v3
    s_add_u32 m0, s47, 0
    s_mov_b64 exec, s[58:59]
    buffer_load_dwordx4 v14, s[8:11], s45 offen offset:0 lds
    s_mov_b64 exec, -1
    v_add_u32 v3, 128, v1
    v_mul_u32_u24 v8, 171, v3
    v_lshrrev_b32 v8, 11, v8
    v_mul_u32_u24 v9, 12, v8
    v_sub_u32 v3, v3, v9
    v_lshl_add_u32 v8, v2, 4, v8
    v_mul_u32_u24 v8, 3840, v8
    v_min_u32 v9, 9, v3
    v_lshl_add_u32 v8, v9, 4, v8
    v_add_u32 v9, -768, v8
    v_add_u32 v8, 432, v8
    v_cmp_gt_u32 vcc, 5, v3
    s_nop 1
    v_cndmask_b32 v16, v8, v9, vcc
    v_cmp_ne_u32 s[62:63], 10, v3
    s_mov_b64 exec, s[60:61]
    buffer_load_dwordx4 v15, s[8:11], s45 offen offset:1024 lds
    s_mov_b64 exec, -1
    s_mov_b64 exec, s[62:63]
    buffer_load_dwordx4 v16, s[8:11], s45 offen offset:2048 lds
    s_mov_b64 exec, -1
    s_add_u32 s44, s44, 128
    s_add_u32 s45, s45, 245760
    s_cmp_eq_u32 s44, s40
    s_cselect_b32 s44, s42, s44
    s_cselect_b32 s45, s43, s45
    s_mov_b32 s28, s84
    s_add_u32 m0, s46, 16384
    s_nop 0
    buffer_load_dwordx4 v10, s[4:7], s44 offen offset:0 lds
    s_mov_b32 s29, s85
    s_mov_b32 s30, 25600
    s_mov_b32 s31, 0x20000
    s_mov_b32 s16, s86
    s_mov_b32 s17, s87
    s_mov_b32 s18, 819200
    s_mov_b32 s19, 0x20000
    s_mov_b32 s12, s100
    s_mov_b32 s13, s101
    s_mov_b32 s14, 23068672
    s_mov_b32 s15, 0x20000
    s_mov_b32 s24, s96
    s_mov_b32 s25, s97
    s_mov_b32 s26, 2621440
    s_mov_b32 s27, 0x20000
    s_mov_b32 s32, s98
    s_mov_b32 s33, s99
    s_mov_b32 s34, 256
    buffer_load_dwordx4 v11, s[4:7], s44 offen offset:1024 lds
    s_mov_b32 s35, 0x20000
    s_mul_i32 s66, s2, 1366
    s_lshr_b32 s66, s66, 16
    s_mul_i32 s67, s66, 48
    s_sub_u32 s67, s2, s67
    s_cmp_lt_u32 s67, 24
    s_cselect_b32 s20, s90, s92
    s_cselect_b32 s21, s91, s93
    s_bitcmp1_b32 s3, 0
    s_cselect_b32 s100, s92, s90
    s_cselect_b32 s101, s93, s91
    s_mov_b32 s64, s94
    s_mov_b32 s65, s95
    s_mov_b32 s22, 1966080
    s_mov_b32 s23, 0x20000
    s_or_b32 s49, s2, s3
    s_cmp_lg_u32 s49, 0
    s_cbranch_scc1 Ln_1
    s_memrealtime s[66:67]
    s_waitcnt lgkmcnt(0)
    s_lshl_b32 s67, s67, 8
    s_or_b32 s67, s67, 0x80
    v_mov_b32 v110, s66
    v_mov_b32 v111, s67
    s_mov_b64 exec, 1
    buffer_store_dwordx2 v[110:111], off, s[32:35], 0 sc1
    s_mov_b64 exec, -1
Ln_1:
    s_mul_i32 s49, s37, 1600
    buffer_load_dwordx4 v12, s[4:7], s44 offen offset:2048 lds
    v_lshlrev_b32 v3, 3, v0
    v_cmp_gt_u32 vcc, 200, v0
    v_mov_b32 v8, 1073741824
    s_nop 0
    v_cndmask_b32 v3, v8, v3, vcc
    buffer_load_dwordx2 v[108:109], v3, s[28:31], s49 offen
    s_mul_i32 s49, s74, 20
    buffer_load_dwordx2 v[122:123], v3, s[28:31], s49 offen
    s_lshl_b32 s48, s3, 11
    s_add_u32 s48, s48, 12288
    buffer_load_dwordx4 v13, s[4:7], s44 offen offset:3072 lds
    v_mov_b32 v128, 0
    v_mov_b32 v129, 0
    v_mov_b32 v130, 0
    v_mov_b32 v131, 0
    v_lshlrev_b32_e64 v3, 4, v0
    ds_write_b128 v3, v[128:131]
    ds_write_b128 v3, v[128:131] offset:4096
    v_min_u32 v3, 3056, v3
    ds_write_b128 v3, v[128:131] offset:9216
    v_mov_b32 v44, 0x3f803f80
    v_mov_b32 v45, 0x3f803f80
    v_mov_b32 v46, 0x3f803f80
    v_mov_b32 v47, 0x3f803f80
    v_mul_u32_u24 v3, 192, v0
    ds_write_b128 v3, v[44:47] offset:45216
    s_add_u32 m0, s47, 12288
    s_mov_b64 exec, s[58:59]
    buffer_load_dwordx4 v14, s[8:11], s45 offen offset:0 lds
    s_mov_b64 exec, -1
    s_waitcnt vmcnt(14)
    v_lshrrev_b32 v4, 4, v1
    v_bfe_u32 v5, v1, 2, 2
    v_and_b32 v6, 3, v1
    v_and_b32 v7, 31, v1
    v_lshrrev_b32 v9, 5, v1
    v_lshlrev_b32 v19, 4, v9
    v_lshlrev_b32_e64 v3, 7, v7
    v_lshl_add_u32 v3, v2, 12, v3
    v_add_u32 v3, 94208, v3
    v_bfe_u32 v8, v7, 1, 3
    v_xor_b32 v8, v8, v9
    v_add_u32 v9, 0, v2
    v_and_b32 v9, 3, v9
    s_mov_b64 exec, s[60:61]
    buffer_load_dwordx4 v15, s[8:11], s45 offen offset:1024 lds
    s_mov_b64 exec, -1
    v_lshlrev_b32 v9, 1, v9
    v_xor_b32 v9, v9, v8
    v_lshl_add_u32 v20, v9, 4, v3
    v_add_u32 v9, 1, v2
    v_and_b32 v9, 3, v9
    v_lshlrev_b32 v9, 1, v9
    v_xor_b32 v9, v9, v8
    v_lshl_add_u32 v21, v9, 4, v3
    v_add_u32 v9, 2, v2
    v_and_b32 v9, 3, v9
    v_lshlrev_b32 v9, 1, v9
    v_xor_b32 v9, v9, v8
    v_lshl_add_u32 v22, v9, 4, v3
    v_add_u32 v9, 3, v2
    s_mov_b64 exec, s[62:63]
    buffer_load_dwordx4 v16, s[8:11], s45 offen offset:2048 lds
    s_mov_b64 exec, -1
    s_add_u32 s44, s44, 128
    s_add_u32 s45, s45, 245760
    s_cmp_eq_u32 s44, s40
    s_cselect_b32 s44, s42, s44
    s_cselect_b32 s45, s43, s45
    v_and_b32 v9, 3, v9
    v_lshlrev_b32 v9, 1, v9
    v_xor_b32 v9, v9, v8
    v_lshl_add_u32 v23, v9, 4, v3
    v_and_b32 v3, 15, v1
    v_and_b32 v8, 1, v4
    v_cmp_eq_u32 vcc, v3, v8
    s_waitcnt lgkmcnt(0)
    s_nop 0
    v_cndmask_b32 v44, 0, v44, vcc
    v_mov_b32 v45, v44
    s_add_u32 m0, s46, 32768
    s_nop 0
    buffer_load_dwordx4 v10, s[4:7], s44 offen offset:0 lds
    v_mov_b32 v46, v44
    v_mov_b32 v47, v44
    v_cmp_eq_u32 vcc, 0, v8
    v_lshlrev_b32 v8, 3, v6
    v_lshrrev_b32_e64 v9, 1, v4
    v_lshl_add_u32 v9, v9, 3, v5
    v_mov_b32 v3, 0x8040703
    v_mov_b32 v128, 0x6020501
    v_cndmask_b32_e64 v3, v3, v128, vcc
    v_bfe_u32 v128, v3, v8, 8
    v_mov_b32 v3, 0x130e120d
    v_mov_b32 v129, 0xf0c0900
    v_cndmask_b32_e64 v3, v3, v129, vcc
    v_bfe_u32 v129, v3, v8, 8
    buffer_load_dwordx4 v11, s[4:7], s44 offen offset:1024 lds
    v_mov_b32 v3, 0x17161514
    v_mov_b32 v130, 0x110b100a
    v_cndmask_b32_e64 v3, v3, v130, vcc
    v_bfe_u32 v130, v3, v8, 8
    v_mov_b32 v3, 0xf0c0e0b
    v_mov_b32 v131, 0xd0a0900
    v_cndmask_b32_e64 v3, v3, v131, vcc
    v_bfe_u32 v131, v3, v8, 8
    v_mul_u32_u24 v3, 192, v9
    v_add_u32 v3, 45056, v3
    v_lshl_add_u32 v132, v128, 3, v3
    v_lshl_add_u32 v133, v129, 3, v3
    v_lshl_add_u32 v134, v130, 3, v3
    v_add_u32 v3, 0, v2
    v_and_b32 v3, 3, v3
    buffer_load_dwordx4 v12, s[4:7], s44 offen offset:2048 lds
    v_mul_u32_u24 v3, 3072, v3
    v_add_u32 v24, v132, v3
    v_add_u32 v28, v133, v3
    v_add_u32 v32, v134, v3
    v_add_u32 v3, 1, v2
    v_and_b32 v3, 3, v3
    v_mul_u32_u24 v3, 3072, v3
    v_add_u32 v25, v132, v3
    v_add_u32 v29, v133, v3
    v_add_u32 v33, v134, v3
    v_add_u32 v3, 2, v2
    v_and_b32 v3, 3, v3
    v_mul_u32_u24 v3, 3072, v3
    v_add_u32 v26, v132, v3
    v_add_u32 v30, v133, v3
    buffer_load_dwordx4 v13, s[4:7], s44 offen offset:3072 lds
    v_add_u32 v34, v134, v3
    v_add_u32 v3, 3, v2
    v_and_b32 v3, 3, v3
    v_mul_u32_u24 v3, 3072, v3
    v_add_u32 v27, v132, v3
    v_add_u32 v31, v133, v3
    v_add_u32 v35, v134, v3
    v_lshlrev_b32 v3, 7, v9
    v_add_u32 v3, 110592, v3
    v_lshrrev_b32 v7, 1, v5
    v_lshlrev_b32 v7, 6, v7
    v_lshl_add_u32 v8, v128, 3, v7
    v_and_b32 v8, 127, v8
    v_add_u32 v39, v3, v8
    v_lshl_add_u32 v8, v131, 3, v7
    s_add_u32 m0, s47, 24576
    s_mov_b64 exec, s[58:59]
    buffer_load_dwordx4 v14, s[8:11], s45 offen offset:0 lds
    s_mov_b64 exec, -1
    v_and_b32 v8, 127, v8
    v_add_u32 v43, v3, v8
    v_cmp_le_u32 vcc, 100, v0
    s_nop 1
    v_cndmask_b32 v8, 0, 1, vcc
    v_mul_u32_u24 v9, 100, v8
    v_sub_u32_e64 v3, v0, v9
    v_add_u32 v9, 80, v3
    v_mov_b32 v7, 100
    v_cmp_le_u32 s[66:67], v7, v9
    v_subrev_u32 v7, 100, v9
    s_nop 0
    v_cndmask_b32 v9, v9, v7, s[66:67]
    v_cndmask_b32 v3, v9, v3, vcc
    v_mul_u32_u24 v8, 960, v8
    s_mov_b64 exec, s[60:61]
    buffer_load_dwordx4 v15, s[8:11], s45 offen offset:1024 lds
    s_mov_b64 exec, -1
    v_lshl_add_u32 v3, v3, 3, v8
    v_add_u32 v3, 2048, v3
    v_cmp_le_u32 vcc, 200, v0
    v_mov_b32 v8, 11904
    s_nop 0
    v_cndmask_b32 v120, v3, v8, vcc
    v_lshrrev_b32 v2, 6, v0
    v_add_u32 v3, 0, v2
    v_and_b32 v3, 3, v3
    v_lshlrev_b32 v3, 11, v3
    v_add_u32 v36, v39, v3
    v_add_u32 v40, v43, v3
    v_add_u32 v3, 1, v2
    v_and_b32 v3, 3, v3
    s_mov_b64 exec, s[62:63]
    buffer_load_dwordx4 v16, s[8:11], s45 offen offset:2048 lds
    s_mov_b64 exec, -1
    s_add_u32 s44, s44, 128
    s_add_u32 s45, s45, 245760
    s_cmp_eq_u32 s44, s40
    s_cselect_b32 s44, s42, s44
    s_cselect_b32 s45, s43, s45
    v_lshlrev_b32 v3, 11, v3
    v_add_u32 v37, v39, v3
    v_add_u32 v41, v43, v3
    v_add_u32 v3, 2, v2
    v_and_b32 v3, 3, v3
    v_lshlrev_b32 v3, 11, v3
    v_add_u32 v38, v39, v3
    v_add_u32 v42, v43, v3
    v_add_u32 v3, 3, v2
    v_and_b32 v3, 3, v3
    v_lshlrev_b32 v3, 11, v3
    v_add_u32 v39, v39, v3
    v_add_u32 v43, v43, v3
    v_lshrrev_b32_e64 v3, 3, v1
    v_lshl_add_u32 v3, v2, 4, v3
    v_mul_u32_u24 v3, 3840, v3
    v_bfe_u32 v8, v1, 4, 1
    v_lshlrev_b32 v8, 2, v8
    v_xor_b32 v8, v1, v8
    v_and_b32 v8, 7, v8
    v_cmp_gt_u32 vcc, 5, v8
    v_lshl_add_u32 v17, v8, 4, v3
    s_waitcnt vmcnt(16) lgkmcnt(0)
    s_barrier
    ds_read_b128 a[0:3], v20 offset:0
    ds_read_b64_tr_b16 v[48:49], v24 offset:0
    ds_read_b64_tr_b16 v[50:51], v24 offset:768
    ds_read_b64_tr_b16 v[52:53], v28 offset:0
    ds_read_b64_tr_b16 v[54:55], v28 offset:768
    ds_read_b64_tr_b16 v[56:57], v32 offset:0
    ds_read_b64_tr_b16 v[58:59], v32 offset:768
    ds_read_b128 a[4:7], v21 offset:0
    ds_read_b64_tr_b16 v[60:61], v25 offset:0
    ds_read_b64_tr_b16 v[62:63], v25 offset:768
    ds_read_b64_tr_b16 v[64:65], v29 offset:0
    ds_read_b64_tr_b16 v[66:67], v29 offset:768
    ds_read_b64_tr_b16 v[68:69], v33 offset:0
    ds_read_b64_tr_b16 v[70:71], v33 offset:768
    s_waitcnt vmcnt(11)
    ds_write_b64 v120, v[108:109]
    ds_write_b64 v120, v[122:123] offset:4096
    s_waitcnt lgkmcnt(9)
    v_mfma_f32_32x32x16_bf16 v[176:191], a[0:3], a[0:3], 0
    ds_read_b128 a[8:11], v22 offset:0
    ds_read_b64_tr_b16 v[72:73], v26 offset:0
    v_mfma_f32_16x16x32_bf16 v[192:195], v[44:47], v[48:51], 0
    v_mfma_f32_16x16x32_bf16 v[196:199], v[44:47], v[52:55], 0
    v_mfma_f32_32x32x16_bf16 v[128:143], v[48:51], a[0:3], 0
    ds_read_b64_tr_b16 v[74:75], v26 offset:768
    ds_read_b64_tr_b16 v[76:77], v30 offset:0
    v_mfma_f32_16x16x32_bf16 v[200:203], v[44:47], v[56:59], 0
    v_mfma_f32_32x32x16_bf16 v[144:159], v[52:55], a[0:3], 0
    ds_read_b64_tr_b16 v[78:79], v30 offset:768
    ds_read_b64_tr_b16 v[80:81], v34 offset:0
    s_add_u32 m0, s46, 49152
    s_nop 0
    buffer_load_dwordx4 v10, s[4:7], s44 offen offset:0 lds
    v_mfma_f32_32x32x16_bf16 v[160:175], v[56:59], a[0:3], 0
    ds_read_b64_tr_b16 v[82:83], v34 offset:768
    buffer_load_dwordx4 v11, s[4:7], s44 offen offset:1024 lds
    s_waitcnt lgkmcnt(9)
    v_mfma_f32_32x32x16_bf16 v[176:191], a[4:7], a[4:7], v[176:191]
    ds_read_b128 a[12:15], v23 offset:0
    ds_read_b64_tr_b16 v[48:49], v27 offset:0
    buffer_load_dwordx4 v12, s[4:7], s44 offen offset:2048 lds
    v_mov_b32 v8, 1073741824
    v_cndmask_b32 v17, v8, v17, vcc
    v_mfma_f32_32x32x16_bf16 v[128:143], v[60:63], a[4:7], v[128:143]
    ds_read_b64_tr_b16 v[50:51], v27 offset:768
    ds_read_b64_tr_b16 v[52:53], v31 offset:0
    v_add_u32 v18, 29696, v17
    s_and_b32 s39, s37, 7
    s_lshr_b32 s38, s37, 3
    v_mfma_f32_32x32x16_bf16 v[144:159], v[64:67], a[4:7], v[144:159]
    ds_read_b64_tr_b16 v[54:55], v31 offset:768
    ds_read_b64_tr_b16 v[56:57], v35 offset:0
    s_getreg_b32 s99, hwreg(HW_REG_XCC_ID)
    s_and_b32 s99, s99, 15
    s_mov_b32 s28, s64
    v_mfma_f32_32x32x16_bf16 v[160:175], v[68:71], a[4:7], v[160:175]
    ds_read_b64_tr_b16 v[58:59], v35 offset:768
    s_mov_b32 s29, s65
    s_mov_b32 s30, 1966080
    s_waitcnt lgkmcnt(7) vmcnt(10)
    s_barrier
    v_mfma_f32_32x32x16_bf16 v[176:191], a[8:11], a[8:11], v[176:191]
    ds_read_b128 a[16:19], v20 offset:16384
    ds_read_b64_tr_b16 v[60:61], v24 offset:12288
    buffer_load_dwordx4 v13, s[4:7], s44 offen offset:3072 lds
    s_mul_i32 s49, s2, 1366
    s_lshr_b32 s49, s49, 16
    v_mfma_f32_32x32x16_bf16 v[128:143], v[72:75], a[8:11], v[128:143]
    ds_read_b64_tr_b16 v[62:63], v24 offset:13056
    ds_read_b64_tr_b16 v[64:65], v28 offset:12288
    s_mul_i32 s50, s49, 48
    s_sub_u32 s50, s2, s50
    v_mfma_f32_32x32x16_bf16 v[144:159], v[76:79], a[8:11], v[144:159]
    ds_read_b64_tr_b16 v[66:67], v28 offset:13056
    ds_read_b64_tr_b16 v[68:69], v32 offset:12288
    s_cmp_ge_u32 s50, 24
    s_cselect_b32 s51, 1, 0
    s_mul_i32 s52, s51, 24
    s_sub_u32 s50, s50, s52
    v_mfma_f32_32x32x16_bf16 v[160:175], v[80:83], a[8:11], v[160:175]
    ds_read_b64_tr_b16 v[70:71], v32 offset:13056
    s_lshl_b32 s72, s49, 4
    s_add_u32 s72, s72, s3
    s_waitcnt lgkmcnt(7)
    v_mfma_f32_32x32x16_bf16 v[176:191], a[12:15], a[12:15], v[176:191]
    ds_read_b128 a[20:23], v21 offset:16384
    ds_read_b64_tr_b16 v[72:73], v25 offset:12288
    s_add_u32 m0, s47, 36864
    s_mov_b64 exec, s[58:59]
    buffer_load_dwordx4 v14, s[8:11], s45 offen offset:0 lds
    s_mov_b64 exec, -1
    s_mul_i32 s72, s72, 24576
    s_lshl_b32 s52, s50, 7
    v_mfma_f32_32x32x16_bf16 v[128:143], v[48:51], a[12:15], v[128:143]
    ds_read_b64_tr_b16 v[74:75], v25 offset:13056
    ds_read_b64_tr_b16 v[76:77], v29 offset:12288
    s_add_u32 s72, s72, s52
    s_lshl_b32 s50, s50, 2
    v_mfma_f32_32x32x16_bf16 v[144:159], v[52:55], a[12:15], v[144:159]
    ds_read_b64_tr_b16 v[78:79], v29 offset:13056
    ds_read_b64_tr_b16 v[80:81], v33 offset:12288
    s_add_u32 s50, s50, s3
    s_lshl_b32 s75, s50, 7
    s_lshl_b32 s52, s51, 6
    v_mfma_f32_32x32x16_bf16 v[160:175], v[56:59], a[12:15], v[160:175]
    ds_read_b64_tr_b16 v[82:83], v33 offset:13056
    s_add_u32 s75, s75, s52
    s_mul_i32 s52, s49, 12288
    s_waitcnt lgkmcnt(7)
    v_mfma_f32_32x32x16_bf16 v[176:191], a[16:19], a[16:19], v[176:191]
    ds_read_b128 a[24:27], v22 offset:16384
    ds_read_b64_tr_b16 v[48:49], v26 offset:12288
    v_mfma_f32_16x16x32_bf16 v[192:195], v[44:47], v[60:63], v[192:195]
    v_mfma_f32_16x16x32_bf16 v[196:199], v[44:47], v[64:67], v[196:199]
    v_mfma_f32_16x16x32_bf16 v[200:203], v[44:47], v[68:71], v[200:203]
    s_mov_b64 exec, s[60:61]
    buffer_load_dwordx4 v15, s[8:11], s45 offen offset:1024 lds
    s_mov_b64 exec, -1
    v_mfma_f32_32x32x16_bf16 v[128:143], v[60:63], a[16:19], v[128:143]
    ds_read_b64_tr_b16 v[50:51], v26 offset:13056
    ds_read_b64_tr_b16 v[52:53], v30 offset:12288
    s_add_u32 s75, s75, s52
    s_add_u32 s75, s75, 8126464
    s_mul_i32 s50, s2, 6554
    v_mfma_f32_32x32x16_bf16 v[144:159], v[64:67], a[16:19], v[144:159]
    ds_read_b64_tr_b16 v[54:55], v30 offset:13056
    ds_read_b64_tr_b16 v[56:57], v34 offset:12288
    s_lshr_b32 s50, s50, 16
    s_mul_i32 s51, s50, 10
    s_sub_u32 s49, s2, s51
    s_mul_i32 s95, s49, 24
    v_mfma_f32_32x32x16_bf16 v[160:175], v[68:71], a[16:19], v[160:175]
    ds_read_b64_tr_b16 v[58:59], v34 offset:13056
    s_add_u32 s95, s95, s50
    s_lshl_b32 s95, s95, 7
    s_add_u32 s95, s95, 22052864
    s_waitcnt lgkmcnt(7)
    v_mfma_f32_32x32x16_bf16 v[176:191], a[20:23], a[20:23], v[176:191]
    ds_read_b128 a[28:31], v23 offset:16384
    ds_read_b64_tr_b16 v[60:61], v27 offset:12288
    s_mov_b64 exec, s[62:63]
    buffer_load_dwordx4 v16, s[8:11], s45 offen offset:2048 lds
    s_mov_b64 exec, -1
    s_add_u32 s44, s44, 128
    s_add_u32 s45, s45, 245760
    s_cmp_eq_u32 s44, s40
    s_cselect_b32 s44, s42, s44
    s_cselect_b32 s45, s43, s45
    s_lshl_b32 s70, s50, 3
    s_add_u32 s70, s70, s3
    v_mfma_f32_32x32x16_bf16 v[128:143], v[72:75], a[20:23], v[128:143]
    ds_read_b64_tr_b16 v[62:63], v27 offset:13056
    ds_read_b64_tr_b16 v[64:65], v31 offset:12288
    s_mul_i32 s70, s70, 10240
    s_lshl_b32 s51, s49, 7
    v_mfma_f32_32x32x16_bf16 v[144:159], v[76:79], a[20:23], v[144:159]
    ds_read_b64_tr_b16 v[66:67], v31 offset:13056
    ds_read_b64_tr_b16 v[68:69], v35 offset:12288
    s_add_u32 s70, s70, s51
    s_lshl_b32 s56, s50, 2
    s_add_u32 s56, s56, s3
    v_mfma_f32_32x32x16_bf16 v[160:175], v[80:83], a[20:23], v[160:175]
    ds_read_b64_tr_b16 v[70:71], v35 offset:13056
    s_mul_i32 s56, s56, 10240
    s_add_u32 s56, s56, s51
    s_waitcnt lgkmcnt(7) vmcnt(7)
    s_barrier
    v_mfma_f32_32x32x16_bf16 v[176:191], a[24:27], a[24:27], v[176:191]
    ds_read_b128 a[32:35], v20 offset:32768
    ds_read_b64_tr_b16 v[72:73], v24 offset:24576
    s_add_u32 m0, s46, 0
    s_nop 0
    buffer_load_dwordx4 v10, s[4:7], s44 offen offset:0 lds
    buffer_load_dwordx4 v11, s[4:7], s44 offen offset:1024 lds
    s_lshl_b32 s49, s49, 2
    v_mfma_f32_32x32x16_bf16 v[128:143], v[48:51], a[24:27], v[128:143]
    ds_read_b64_tr_b16 v[74:75], v24 offset:25344
    ds_read_b64_tr_b16 v[76:77], v28 offset:24576
    s_add_u32 s49, s49, s3
    s_mul_i32 s51, s49, 205
    s_lshr_b32 s51, s51, 10
    v_mfma_f32_32x32x16_bf16 v[144:159], v[52:55], a[24:27], v[144:159]
    ds_read_b64_tr_b16 v[78:79], v28 offset:25344
    ds_read_b64_tr_b16 v[80:81], v32 offset:24576
    s_mul_i32 s52, s51, 5
    s_sub_u32 s52, s49, s52
    s_mul_i32 s71, s51, 245760
    v_mfma_f32_32x32x16_bf16 v[160:175], v[56:59], a[24:27], v[160:175]
    ds_read_b64_tr_b16 v[82:83], v32 offset:25344
    s_lshl_b32 s52, s52, 10
    s_add_u32 s71, s71, s52
    s_waitcnt lgkmcnt(7)
    v_mfma_f32_32x32x16_bf16 v[176:191], a[28:31], a[28:31], v[176:191]
    ds_read_b128 a[36:39], v21 offset:32768
    ds_read_b64_tr_b16 v[48:49], v25 offset:24576
    buffer_load_dwordx4 v12, s[4:7], s44 offen offset:2048 lds
    buffer_load_dwordx4 v13, s[4:7], s44 offen offset:3072 lds
    s_mul_i32 s57, s51, 102400
    v_mfma_f32_32x32x16_bf16 v[128:143], v[60:63], a[28:31], v[128:143]
    ds_read_b64_tr_b16 v[50:51], v25 offset:25344
    ds_read_b64_tr_b16 v[52:53], v29 offset:24576
    s_add_u32 s57, s57, s52
    s_mul_i32 s52, s50, 5120
    s_add_u32 s57, s57, s52
    v_mfma_f32_32x32x16_bf16 v[144:159], v[64:67], a[28:31], v[144:159]
    ds_read_b64_tr_b16 v[54:55], v29 offset:25344
    ds_read_b64_tr_b16 v[56:57], v33 offset:24576
    s_add_u32 s57, s57, 20971520
    s_mul_i32 s52, s50, 10240
    s_add_u32 s71, s71, s52
    v_mfma_f32_32x32x16_bf16 v[160:175], v[68:71], a[28:31], v[160:175]
    ds_read_b64_tr_b16 v[58:59], v33 offset:25344
    s_add_u32 s71, s71, 18874368
    s_cmp_lt_u32 s2, 240
    s_cselect_b32 s72, s72, 1073741824
    s_cselect_b32 s75, s75, 1073741824
    s_cselect_b32 s71, s71, 1073741824
    s_cselect_b32 s70, s70, 1073741824
    s_cselect_b32 s95, s95, 1073741824
    s_waitcnt lgkmcnt(7)
    v_mfma_f32_32x32x16_bf16 v[176:191], a[32:35], a[32:35], v[176:191]
    ds_read_b128 a[40:43], v22 offset:32768
    ds_read_b64_tr_b16 v[60:61], v26 offset:24576
    v_mfma_f32_16x16x32_bf16 v[192:195], v[44:47], v[72:75], v[192:195]
    v_mfma_f32_16x16x32_bf16 v[196:199], v[44:47], v[76:79], v[196:199]
    v_mfma_f32_16x16x32_bf16 v[200:203], v[44:47], v[80:83], v[200:203]
    s_add_u32 m0, s47, 0
    s_mov_b64 exec, s[58:59]
    buffer_load_dwordx4 v14, s[8:11], s45 offen offset:0 lds
    s_mov_b64 exec, -1
    v_mfma_f32_32x32x16_bf16 v[128:143], v[72:75], a[32:35], v[128:143]
    ds_read_b64_tr_b16 v[62:63], v26 offset:25344
    ds_read_b64_tr_b16 v[64:65], v30 offset:24576
    s_mov_b64 exec, s[60:61]
    buffer_load_dwordx4 v15, s[8:11], s45 offen offset:1024 lds
    s_mov_b64 exec, -1
    s_cmp_lt_u32 s2, 200
    s_cselect_b32 s57, s57, 1073741824
    s_cselect_b32 s56, s56, 1073741824
    v_bfe_u32 v3, v1, 4, 1
    s_and_b32 s49, s3, 1
    v_mfma_f32_32x32x16_bf16 v[144:159], v[76:79], a[32:35], v[144:159]
    ds_read_b64_tr_b16 v[66:67], v30 offset:25344
    ds_read_b64_tr_b16 v[68:69], v34 offset:24576
    s_lshl_b32 s49, s49, 1
    v_or_b32 v3, s49, v3
    v_lshlrev_b32 v3, 1, v3
    v_and_b32 v4, 7, v1
    v_mfma_f32_32x32x16_bf16 v[160:175], v[80:83], a[32:35], v[160:175]
    ds_read_b64_tr_b16 v[70:71], v34 offset:25344
    v_xor_b32 v3, v3, v4
    v_lshlrev_b32 v3, 4, v3
    v_lshrrev_b32 v2, 3, v1
    s_waitcnt lgkmcnt(7)
    v_mfma_f32_32x32x16_bf16 v[176:191], a[36:39], a[36:39], v[176:191]
    ds_read_b128 a[44:47], v23 offset:32768
    ds_read_b64_tr_b16 v[72:73], v27 offset:24576
    s_mov_b64 exec, s[62:63]
    buffer_load_dwordx4 v16, s[8:11], s45 offen offset:2048 lds
    s_mov_b64 exec, -1
    s_add_u32 s44, s44, 128
    s_add_u32 s45, s45, 245760
    s_cmp_eq_u32 s44, s40
    s_cselect_b32 s44, s42, s44
    s_cselect_b32 s45, s43, s45
    v_mul_u32_u24 v4, 3072, v2
    v_add_u32_e64 v4, v4, v3
    v_mfma_f32_32x32x16_bf16 v[128:143], v[48:51], a[36:39], v[128:143]
    ds_read_b64_tr_b16 v[74:75], v27 offset:25344
    ds_read_b64_tr_b16 v[76:77], v31 offset:24576
    v_accvgpr_write_b32 a160, v4
    v_mul_u32_u24 v4, 1280, v2
    v_mfma_f32_32x32x16_bf16 v[144:159], v[52:55], a[36:39], v[144:159]
    ds_read_b64_tr_b16 v[78:79], v31 offset:25344
    ds_read_b64_tr_b16 v[80:81], v35 offset:24576
    v_add_u32 v4, v4, v3
    v_accvgpr_write_b32 a161, v4
    s_lshl_b32 s96, s3, 10
    v_mfma_f32_32x32x16_bf16 v[160:175], v[56:59], a[36:39], v[160:175]
    ds_read_b64_tr_b16 v[82:83], v35 offset:25344
    s_add_u32 s96, s96, 12288
    v_lshrrev_b32 v2, 4, v1
    s_waitcnt lgkmcnt(7) vmcnt(7)
    s_barrier
    v_mfma_f32_32x32x16_bf16 v[176:191], a[40:43], a[40:43], v[176:191]
    ds_read_b128 a[48:51], v20 offset:49152
    ds_read_b64_tr_b16 v[48:49], v24 offset:36864
    s_add_u32 m0, s46, 16384
    s_nop 0
    buffer_load_dwordx4 v10, s[4:7], s44 offen offset:0 lds
    buffer_load_dwordx4 v11, s[4:7], s44 offen offset:1024 lds
    v_bfe_u32 v3, v1, 2, 2
    v_mfma_f32_32x32x16_bf16 v[128:143], v[60:63], a[40:43], v[128:143]
    ds_read_b64_tr_b16 v[50:51], v24 offset:37632
    ds_read_b64_tr_b16 v[52:53], v28 offset:36864
    v_lshl_add_u32 v4, v2, 3, v3
    v_lshlrev_b32_e64 v4, 7, v4
    v_add_u32 v4, 12288, v4
    v_mfma_f32_32x32x16_bf16 v[144:159], v[64:67], a[40:43], v[144:159]
    ds_read_b64_tr_b16 v[54:55], v28 offset:37632
    ds_read_b64_tr_b16 v[56:57], v32 offset:36864
    v_lshrrev_b32 v3, 1, v3
    v_and_b32 v5, 1, v2
    v_lshl_or_b32 v3, v5, 1, v3
    v_mfma_f32_32x32x16_bf16 v[160:175], v[68:71], a[40:43], v[160:175]
    ds_read_b64_tr_b16 v[58:59], v32 offset:37632
    v_xor_b32 v3, s3, v3
    v_lshl_add_u32 v4, v3, 5, v4
    s_waitcnt lgkmcnt(7)
    v_mfma_f32_32x32x16_bf16 v[176:191], a[44:47], a[44:47], v[176:191]
    ds_read_b128 a[52:55], v21 offset:49152
    ds_read_b64_tr_b16 v[60:61], v25 offset:36864
    buffer_load_dwordx4 v12, s[4:7], s44 offen offset:2048 lds
    buffer_load_dwordx4 v13, s[4:7], s44 offen offset:3072 lds
    v_and_b32_e64 v5, 1, v1
    v_mfma_f32_32x32x16_bf16 v[128:143], v[72:75], a[44:47], v[128:143]
    ds_read_b64_tr_b16 v[62:63], v25 offset:37632
    ds_read_b64_tr_b16 v[64:65], v29 offset:36864
    v_bfe_u32 v6, v1, 1, 1
    v_lshl_add_u32 v7, v5, 4, v4
    v_lshl_add_u32 v7, v6, 3, v7
    v_mfma_f32_32x32x16_bf16 v[144:159], v[76:79], a[44:47], v[144:159]
    ds_read_b64_tr_b16 v[66:67], v29 offset:37632
    ds_read_b64_tr_b16 v[68:69], v33 offset:36864
    v_accvgpr_write_b32 a162, v7
    v_lshl_add_u32 v7, v6, 4, v4
    v_lshl_add_u32 v7, v5, 3, v7
    v_mfma_f32_32x32x16_bf16 v[160:175], v[80:83], a[44:47], v[160:175]
    ds_read_b64_tr_b16 v[70:71], v33 offset:37632
    v_accvgpr_write_b32 a163, v7
    v_accvgpr_read_b32 v218, a160
    v_accvgpr_read_b32 v219, a161
    s_waitcnt lgkmcnt(7)
    v_mfma_f32_32x32x16_bf16 v[176:191], a[48:51], a[48:51], v[176:191]
    ds_read_b128 a[56:59], v22 offset:49152
    ds_read_b64_tr_b16 v[72:73], v26 offset:36864
    v_mfma_f32_16x16x32_bf16 v[192:195], v[44:47], v[48:51], v[192:195]
    v_mfma_f32_16x16x32_bf16 v[196:199], v[44:47], v[52:55], v[196:199]
    v_mfma_f32_16x16x32_bf16 v[200:203], v[44:47], v[56:59], v[200:203]
    s_add_u32 m0, s47, 12288
    s_mov_b64 exec, s[58:59]
    buffer_load_dwordx4 v14, s[8:11], s45 offen offset:0 lds
    s_mov_b64 exec, -1
    s_mov_b64 exec, s[60:61]
    buffer_load_dwordx4 v15, s[8:11], s45 offen offset:1024 lds
    s_mov_b64 exec, -1
    v_mfma_f32_32x32x16_bf16 v[128:143], v[48:51], a[48:51], v[128:143]
    ds_read_b64_tr_b16 v[74:75], v26 offset:37632
    ds_read_b64_tr_b16 v[76:77], v30 offset:36864
    v_lshrrev_b32 v5, 1, v2
    v_and_b32 v6, 1, v2
    v_and_b32 v3, 15, v1
    v_mul_u32_u24 v4, 1280, v3
    v_lshl_add_u32 v7, v2, 3, v4
    v_mfma_f32_32x32x16_bf16 v[144:159], v[52:55], a[48:51], v[144:159]
    ds_read_b64_tr_b16 v[78:79], v30 offset:37632
    ds_read_b64_tr_b16 v[80:81], v34 offset:36864
    v_accvgpr_write_b32 a248, v7
    v_lshl_add_u32 v7, v5, 4, v4
    v_lshl_add_u32 v7, v6, 5, v7
    v_accvgpr_write_b32 a247, v7
    v_lshlrev_b32_e64 v4, 4, v3
    v_mfma_f32_32x32x16_bf16 v[160:175], v[56:59], a[48:51], v[160:175]
    ds_read_b64_tr_b16 v[82:83], v34 offset:37632
    v_lshl_add_u32 v7, v5, 9, v4
    v_lshl_add_u32 v8, v6, 10, v7
    v_accvgpr_write_b32 a245, v8
    v_lshl_add_u32 v8, v6, 3, v7
    s_waitcnt lgkmcnt(7)
    v_mfma_f32_32x32x16_bf16 v[176:191], a[52:55], a[52:55], v[176:191]
    ds_read_b128 a[60:63], v23 offset:49152
    ds_read_b64_tr_b16 v[48:49], v27 offset:36864
    s_mov_b64 exec, s[62:63]
    buffer_load_dwordx4 v16, s[8:11], s45 offen offset:2048 lds
    s_mov_b64 exec, -1
    s_add_u32 s44, s44, 128
    s_add_u32 s45, s45, 245760
    s_cmp_eq_u32 s44, s40
    s_cselect_b32 s44, s42, s44
    s_cselect_b32 s45, s43, s45
    v_accvgpr_write_b32 a246, v8
    v_mul_u32_u24 v7, 20480, v6
    v_add_u32_e64 v7, v7, v4
    v_mfma_f32_32x32x16_bf16 v[128:143], v[60:63], a[52:55], v[128:143]
    ds_read_b64_tr_b16 v[50:51], v27 offset:37632
    ds_read_b64_tr_b16 v[52:53], v31 offset:36864
    v_lshl_add_u32 v8, v5, 3, v7
    v_accvgpr_write_b32 a164, v8
    v_mul_u32_u24 v8, 768, v5
    v_mfma_f32_32x32x16_bf16 v[144:159], v[64:67], a[52:55], v[144:159]
    ds_read_b64_tr_b16 v[54:55], v31 offset:37632
    ds_read_b64_tr_b16 v[56:57], v35 offset:36864
    v_add_u32 v8, v8, v7
    v_accvgpr_write_b32 a165, v8
    v_mul_u32_u24 v7, 49152, v6
    v_add_u32 v7, v7, v4
    v_mfma_f32_32x32x16_bf16 v[160:175], v[68:71], a[52:55], v[160:175]
    ds_read_b64_tr_b16 v[58:59], v35 offset:37632
    v_lshl_add_u32 v7, v5, 8, v7
    v_accvgpr_write_b32 a249, v7
    s_lshl_b32 s49, s36, 1
    s_waitcnt lgkmcnt(7) vmcnt(7)
    s_barrier
    v_mfma_f32_32x32x16_bf16 v[176:191], a[56:59], a[56:59], v[176:191]
    ds_read_b128 a[64:67], v20 offset:0
    ds_read_b64_tr_b16 v[60:61], v24 offset:0
    s_add_u32 m0, s46, 32768
    s_nop 0
    buffer_load_dwordx4 v10, s[4:7], s44 offen offset:0 lds
    buffer_load_dwordx4 v11, s[4:7], s44 offen offset:1024 lds
    s_add_u32 s49, s49, s38
    s_lshl_b32 s49, s49, 2
    v_mfma_f32_32x32x16_bf16 v[128:143], v[72:75], a[56:59], v[128:143]
    ds_read_b64_tr_b16 v[62:63], v24 offset:768
    ds_read_b64_tr_b16 v[64:65], v28 offset:0
    s_mul_i32 s87, s49, 49152
    s_add_u32 s49, s49, s3
    s_mul_i32 s84, s49, 20480
    s_mul_i32 s50, s39, 160
    v_mfma_f32_32x32x16_bf16 v[144:159], v[76:79], a[56:59], v[144:159]
    ds_read_b64_tr_b16 v[66:67], v28 offset:768
    ds_read_b64_tr_b16 v[68:69], v32 offset:0
    s_add_u32 s78, s84, s50
    s_add_u32 s84, s84, 2097152
    s_mul_i32 s50, s3, 12288
    s_add_u32 s87, s87, s50
    v_mfma_f32_32x32x16_bf16 v[160:175], v[80:83], a[56:59], v[160:175]
    ds_read_b64_tr_b16 v[70:71], v32 offset:768
    s_add_u32 s87, s87, 8388608
    s_lshr_b32 s50, s49, 1
    s_mul_i32 s81, s50, 40960
    s_waitcnt lgkmcnt(7)
    v_mfma_f32_32x32x16_bf16 v[176:191], a[60:63], a[60:63], v[176:191]
    ds_read_b128 a[68:71], v21 offset:0
    ds_read_b64_tr_b16 v[72:73], v25 offset:0
    buffer_load_dwordx4 v12, s[4:7], s44 offen offset:2048 lds
    buffer_load_dwordx4 v13, s[4:7], s44 offen offset:3072 lds
    s_mul_i32 s50, s39, 5120
    s_add_u32 s81, s81, s50
    v_mfma_f32_32x32x16_bf16 v[128:143], v[48:51], a[60:63], v[128:143]
    ds_read_b64_tr_b16 v[74:75], v25 offset:768
    ds_read_b64_tr_b16 v[76:77], v29 offset:0
    s_and_b32 s50, s3, 1
    s_lshl_b32 s50, s50, 8
    s_add_u32 s81, s81, s50
    s_add_u32 s81, s81, 5242880
    v_mfma_f32_32x32x16_bf16 v[144:159], v[52:55], a[60:63], v[144:159]
    ds_read_b64_tr_b16 v[78:79], v29 offset:768
    ds_read_b64_tr_b16 v[80:81], v33 offset:0
    s_add_u32 s82, s81, 4096
    s_lshl_b32 s83, s36, 3
    s_add_u32 s83, s83, s39
    s_lshl_b32 s83, s83, 10
    v_mfma_f32_32x32x16_bf16 v[160:175], v[56:59], a[60:63], v[160:175]
    ds_read_b64_tr_b16 v[82:83], v33 offset:768
    s_and_b32 s50, s49, 7
    s_lshl_b32 s50, s50, 7
    s_add_u32 s83, s83, s50
    s_waitcnt lgkmcnt(7)
    v_mfma_f32_32x32x16_bf16 v[176:191], a[64:67], a[64:67], v[176:191]
    ds_read_b128 a[72:75], v22 offset:0
    ds_read_b64_tr_b16 v[48:49], v26 offset:0
    v_mfma_f32_16x16x32_bf16 v[192:195], v[44:47], v[60:63], v[192:195]
    v_mfma_f32_16x16x32_bf16 v[196:199], v[44:47], v[64:67], v[196:199]
    v_mfma_f32_16x16x32_bf16 v[200:203], v[44:47], v[68:71], v[200:203]
    s_add_u32 m0, s47, 24576
    s_mov_b64 exec, s[58:59]
    buffer_load_dwordx4 v14, s[8:11], s45 offen offset:0 lds
    s_mov_b64 exec, -1
    s_mov_b64 exec, s[60:61]
    buffer_load_dwordx4 v15, s[8:11], s45 offen offset:1024 lds
    s_mov_b64 exec, -1
    v_mfma_f32_32x32x16_bf16 v[128:143], v[60:63], a[64:67], v[128:143]
    ds_read_b64_tr_b16 v[50:51], v26 offset:768
    ds_read_b64_tr_b16 v[52:53], v30 offset:0
    s_add_u32 s83, s83, 7864320
    s_lshl_b32 s49, s36, 2
    s_add_u32 s49, s49, s3
    s_mul_i32 s80, s49, 40960
    v_mfma_f32_32x32x16_bf16 v[144:159], v[64:67], a[64:67], v[144:159]
    ds_read_b64_tr_b16 v[54:55], v30 offset:768
    ds_read_b64_tr_b16 v[56:57], v34 offset:0
    s_lshl_b32 s50, s74, 4
    s_add_u32 s80, s80, s50
    s_add_u32 s80, s80, 2097152
    s_lshl_b32 s49, s36, 2
    s_add_u32 s49, s49, s3
    v_mfma_f32_32x32x16_bf16 v[160:175], v[68:71], a[64:67], v[160:175]
    ds_read_b64_tr_b16 v[58:59], v34 offset:768
    s_mul_i32 s85, s49, 40960
    s_add_u32 s85, s85, 5242880
    s_mul_i32 s79, s49, 98304
    s_mul_i32 s50, s37, 3072
    s_waitcnt lgkmcnt(7)
    v_mfma_f32_32x32x16_bf16 v[176:191], a[68:71], a[68:71], v[176:191]
    ds_read_b128 a[76:79], v23 offset:0
    ds_read_b64_tr_b16 v[60:61], v27 offset:0
    s_mov_b64 exec, s[62:63]
    buffer_load_dwordx4 v16, s[8:11], s45 offen offset:2048 lds
    s_mov_b64 exec, -1
    s_add_u32 s44, s44, 128
    s_add_u32 s45, s45, 245760
    s_cmp_eq_u32 s44, s40
    s_cselect_b32 s44, s42, s44
    s_cselect_b32 s45, s43, s45
    s_add_u32 s79, s79, s50
    s_add_u32 s79, s79, 8388608
    s_lshl_b32 s86, s36, 13
    v_mfma_f32_32x32x16_bf16 v[128:143], v[72:75], a[68:71], v[128:143]
    ds_read_b64_tr_b16 v[62:63], v27 offset:768
    ds_read_b64_tr_b16 v[64:65], v31 offset:0
    s_lshl_b32 s50, s3, 8
    s_add_u32 s86, s86, s50
    s_add_u32 s86, s86, 7864320
    s_mul_i32 s88, s39, 245760
    v_mfma_f32_32x32x16_bf16 v[144:159], v[76:79], a[68:71], v[144:159]
    ds_read_b64_tr_b16 v[66:67], v31 offset:768
    ds_read_b64_tr_b16 v[68:69], v35 offset:0
    s_mul_i32 s50, s3, 61440
    s_add_u32 s88, s88, s50
    s_add_u32 s88, s88, 18874368
    s_lshr_b32 s50, s3, 1
    v_mfma_f32_32x32x16_bf16 v[160:175], v[80:83], a[68:71], v[160:175]
    ds_read_b64_tr_b16 v[70:71], v35 offset:768
    s_mul_i32 s89, s50, 49152
    s_mul_i32 s51, s37, 192
    s_add_u32 s89, s89, s51
    s_waitcnt lgkmcnt(7) vmcnt(7)
    s_barrier
    v_mfma_f32_32x32x16_bf16 v[176:191], a[72:75], a[72:75], v[176:191]
    ds_read_b128 a[80:83], v20 offset:16384
    ds_read_b64_tr_b16 v[72:73], v24 offset:12288
    s_add_u32 m0, s46, 49152
    s_nop 0
    buffer_load_dwordx4 v10, s[4:7], s44 offen offset:0 lds
    buffer_load_dwordx4 v11, s[4:7], s44 offen offset:1024 lds
    s_mul_i32 s90, s50, 3072
    s_and_b32 s50, s3, 1
    v_mfma_f32_32x32x16_bf16 v[128:143], v[48:51], a[72:75], v[128:143]
    ds_read_b64_tr_b16 v[74:75], v24 offset:13056
    ds_read_b64_tr_b16 v[76:77], v28 offset:12288
    s_mul_i32 s50, s50, 6176
    s_add_u32 s90, s90, s50
    s_add_u32 s90, s90, 12288
    v_lshrrev_b32_e64 v2, 5, v1
    v_mfma_f32_32x32x16_bf16 v[144:159], v[52:55], a[72:75], v[144:159]
    ds_read_b64_tr_b16 v[78:79], v28 offset:13056
    ds_read_b64_tr_b16 v[80:81], v32 offset:12288
    v_bfe_u32 v3, v1, 2, 2
    v_lshl_add_u32 v2, v2, 3, v3
    v_mul_u32_u24 v2, 192, v2
    v_bfe_u32 v3, v1, 4, 1
    v_mfma_f32_32x32x16_bf16 v[160:175], v[56:59], a[72:75], v[160:175]
    ds_read_b64_tr_b16 v[82:83], v32 offset:13056
    v_mul_u32_u24 v3, 6176, v3
    v_add_u32 v2, v2, v3
    v_and_b32 v3, 1, v1
    s_waitcnt lgkmcnt(7)
    v_mfma_f32_32x32x16_bf16 v[176:191], a[76:79], a[76:79], v[176:191]
    ds_read_b128 a[84:87], v21 offset:16384
    ds_read_b64_tr_b16 v[48:49], v25 offset:12288
    buffer_load_dwordx4 v12, s[4:7], s44 offen offset:2048 lds
    buffer_load_dwordx4 v13, s[4:7], s44 offen offset:3072 lds
    v_lshl_add_u32 v2, v3, 4, v2
    v_bfe_u32 v3, v1, 1, 1
    v_mfma_f32_32x32x16_bf16 v[128:143], v[60:63], a[76:79], v[128:143]
    ds_read_b64_tr_b16 v[50:51], v25 offset:13056
    ds_read_b64_tr_b16 v[52:53], v29 offset:12288
    v_lshl_add_u32 v2, v3, 3, v2
    v_add_u32 v2, 12288, v2
    v_accvgpr_write_b32 a251, v2
    s_xor_b32 s51, s37, 1
    v_mfma_f32_32x32x16_bf16 v[144:159], v[64:67], a[76:79], v[144:159]
    ds_read_b64_tr_b16 v[54:55], v29 offset:13056
    ds_read_b64_tr_b16 v[56:57], v33 offset:12288
    s_lshl_b32 s91, s51, 16
    s_add_u32 s91, s91, 65536
    s_mul_i32 s92, s37, 768
    s_add_u32 s92, s92, 8126464
    v_mfma_f32_32x32x16_bf16 v[160:175], v[68:71], a[76:79], v[160:175]
    ds_read_b64_tr_b16 v[58:59], v33 offset:13056
    s_lshl_b32 s94, s51, 11
    s_add_u32 s94, s94, 22020096
    s_lshl_b32 s93, s37, 4
    s_waitcnt lgkmcnt(7)
    v_mfma_f32_32x32x16_bf16 v[176:191], a[80:83], a[80:83], v[176:191]
    ds_read_b128 a[88:91], v22 offset:16384
    ds_read_b64_tr_b16 v[60:61], v26 offset:12288
    v_mfma_f32_16x16x32_bf16 v[192:195], v[44:47], v[72:75], v[192:195]
    v_mfma_f32_16x16x32_bf16 v[196:199], v[44:47], v[76:79], v[196:199]
    v_mfma_f32_16x16x32_bf16 v[200:203], v[44:47], v[80:83], v[200:203]
    s_add_u32 m0, s47, 36864
    s_mov_b64 exec, s[58:59]
    buffer_load_dwordx4 v14, s[8:11], s45 offen offset:0 lds
    s_mov_b64 exec, -1
    s_mov_b64 exec, s[60:61]
    buffer_load_dwordx4 v15, s[8:11], s45 offen offset:1024 lds
    s_mov_b64 exec, -1
    v_mfma_f32_32x32x16_bf16 v[128:143], v[72:75], a[80:83], v[128:143]
    ds_read_b64_tr_b16 v[62:63], v26 offset:13056
    ds_read_b64_tr_b16 v[64:65], v30 offset:12288
    s_add_u32 s93, s93, s36
    s_lshl_b32 s93, s93, 7
    s_add_u32 s93, s93, 22020096
    s_lshl_b32 s97, s36, 7
    v_mfma_f32_32x32x16_bf16 v[144:159], v[76:79], a[80:83], v[144:159]
    ds_read_b64_tr_b16 v[66:67], v30 offset:13056
    ds_read_b64_tr_b16 v[68:69], v34 offset:12288
    s_add_u32 s97, s97, 4096
    s_lshl_b32 s50, s37, 3
    s_add_u32 s73, s97, s50
    v_and_b32 v2, 15, v1
    v_lshlrev_b32_e64 v3, 3, v2
    v_mfma_f32_32x32x16_bf16 v[160:175], v[80:83], a[80:83], v[160:175]
    ds_read_b64_tr_b16 v[70:71], v34 offset:13056
    v_accvgpr_write_b32 a166, v3
    v_lshlrev_b32 v2, 7, v2
    v_accvgpr_write_b32 a167, v2
    s_mul_i32 s50, s39, 80
    s_waitcnt lgkmcnt(7)
    v_mfma_f32_32x32x16_bf16 v[176:191], a[84:87], a[84:87], v[176:191]
    ds_read_b128 a[92:95], v23 offset:16384
    ds_read_b64_tr_b16 v[72:73], v27 offset:12288
    s_mov_b64 exec, s[62:63]
    buffer_load_dwordx4 v16, s[8:11], s45 offen offset:2048 lds
    s_mov_b64 exec, -1
    s_add_u32 s44, s44, 128
    s_add_u32 s45, s45, 245760
    s_cmp_eq_u32 s44, s40
    s_cselect_b32 s44, s42, s44
    s_cselect_b32 s45, s43, s45
    s_lshr_b32 s50, s50, 6
    s_mul_i32 s50, s50, 3072
    v_min_u32_e64 v2, 47, v1
    v_mfma_f32_32x32x16_bf16 v[128:143], v[48:51], a[84:87], v[128:143]
    ds_read_b64_tr_b16 v[74:75], v27 offset:13056
    ds_read_b64_tr_b16 v[76:77], v31 offset:12288
    v_lshlrev_b32 v2, 7, v2
    v_add_u32 v2, s50, v2
    v_accvgpr_write_b32 a250, v2
    v_mfma_f32_32x32x16_bf16 v[144:159], v[52:55], a[84:87], v[144:159]
    ds_read_b64_tr_b16 v[78:79], v31 offset:13056
    ds_read_b64_tr_b16 v[80:81], v35 offset:12288
    v_add_u32 v3, 0, v1
    v_mul_u32_u24 v8, 171, v3
    v_lshrrev_b32 v8, 11, v8
    v_mul_u32_u24 v9, 12, v8
    v_mfma_f32_32x32x16_bf16 v[160:175], v[56:59], a[84:87], v[160:175]
    ds_read_b64_tr_b16 v[82:83], v35 offset:13056
    v_sub_u32 v3, v3, v9
    v_mul_u32_u24 v8, 3072, v8
    v_lshl_add_u32 v8, v3, 4, v8
    s_waitcnt lgkmcnt(7) vmcnt(7)
    s_barrier
    v_mfma_f32_32x32x16_bf16 v[176:191], a[88:91], a[88:91], v[176:191]
    ds_read_b128 a[96:99], v20 offset:32768
    ds_read_b64_tr_b16 v[48:49], v24 offset:24576
    s_add_u32 m0, s46, 0
    s_nop 0
    buffer_load_dwordx4 v10, s[4:7], s44 offen offset:0 lds
    buffer_load_dwordx4 v11, s[4:7], s44 offen offset:1024 lds
    v_subrev_u32_e64 v8, 0, v8
    v_accvgpr_write_b32 a252, v8
    v_mfma_f32_32x32x16_bf16 v[128:143], v[60:63], a[88:91], v[128:143]
    ds_read_b64_tr_b16 v[50:51], v24 offset:25344
    ds_read_b64_tr_b16 v[52:53], v28 offset:24576
    v_add_u32 v3, 64, v1
    v_mul_u32_u24 v8, 171, v3
    v_lshrrev_b32 v8, 11, v8
    v_mul_u32_u24_e64 v9, 12, v8
    v_mfma_f32_32x32x16_bf16 v[144:159], v[64:67], a[88:91], v[144:159]
    ds_read_b64_tr_b16 v[54:55], v28 offset:25344
    ds_read_b64_tr_b16 v[56:57], v32 offset:24576
    v_sub_u32_e64 v3, v3, v9
    v_mul_u32_u24 v8, 3072, v8
    v_lshl_add_u32 v8, v3, 4, v8
    v_subrev_u32 v8, 1024, v8
    v_mfma_f32_32x32x16_bf16 v[160:175], v[68:71], a[88:91], v[160:175]
    ds_read_b64_tr_b16 v[58:59], v32 offset:25344
    v_accvgpr_write_b32 a253, v8
    v_add_u32 v3, 128, v1
    v_mul_u32_u24 v8, 171, v3
    v_lshrrev_b32 v8, 11, v8
    s_waitcnt lgkmcnt(7)
    v_mfma_f32_32x32x16_bf16 v[176:191], a[92:95], a[92:95], v[176:191]
    ds_read_b128 a[100:103], v21 offset:32768
    ds_read_b64_tr_b16 v[60:61], v25 offset:24576
    buffer_load_dwordx4 v12, s[4:7], s44 offen offset:2048 lds
    buffer_load_dwordx4 v13, s[4:7], s44 offen offset:3072 lds
    v_mul_u32_u24 v9, 12, v8
    v_sub_u32 v3, v3, v9
    v_mfma_f32_32x32x16_bf16 v[128:143], v[72:75], a[92:95], v[128:143]
    ds_read_b64_tr_b16 v[62:63], v25 offset:25344
    ds_read_b64_tr_b16 v[64:65], v29 offset:24576
    v_mul_u32_u24 v8, 3072, v8
    v_lshl_add_u32 v8, v3, 4, v8
    v_subrev_u32 v8, 2048, v8
    v_accvgpr_write_b32 a254, v8
    v_mfma_f32_32x32x16_bf16 v[144:159], v[76:79], a[92:95], v[144:159]
    ds_read_b64_tr_b16 v[66:67], v29 offset:25344
    ds_read_b64_tr_b16 v[68:69], v33 offset:24576
    v_cmp_le_u32 vcc, 96, v0
    s_nop 1
    v_cndmask_b32 v8, 0, 1, vcc
    v_mul_u32_u24 v9, 96, v8
    v_sub_u32 v3, v0, v9
    v_mfma_f32_32x32x16_bf16 v[160:175], v[80:83], a[92:95], v[160:175]
    ds_read_b64_tr_b16 v[70:71], v33 offset:25344
    v_subrev_u32 v210, 192, v0
    v_cmp_le_u32 vcc, 24, v210
    s_nop 1
    v_cndmask_b32 v211, 0, 1, vcc
    s_waitcnt lgkmcnt(7)
    v_mfma_f32_32x32x16_bf16 v[176:191], a[96:99], a[96:99], v[176:191]
    ds_read_b128 a[104:107], v22 offset:32768
    ds_read_b64_tr_b16 v[72:73], v26 offset:24576
    v_mfma_f32_16x16x32_bf16 v[192:195], v[44:47], v[48:51], v[192:195]
    v_mfma_f32_16x16x32_bf16 v[196:199], v[44:47], v[52:55], v[196:199]
    v_mfma_f32_16x16x32_bf16 v[200:203], v[44:47], v[56:59], v[200:203]
    s_add_u32 m0, s47, 0
    s_mov_b64 exec, s[58:59]
    buffer_load_dwordx4 v14, s[8:11], s45 offen offset:0 lds
    s_mov_b64 exec, -1
    s_mov_b64 exec, s[60:61]
    buffer_load_dwordx4 v15, s[8:11], s45 offen offset:1024 lds
    s_mov_b64 exec, -1
    v_mfma_f32_32x32x16_bf16 v[128:143], v[48:51], a[96:99], v[128:143]
    ds_read_b64_tr_b16 v[74:75], v26 offset:25344
    ds_read_b64_tr_b16 v[76:77], v30 offset:24576
    v_mul_u32_u24 v9, 24, v211
    v_sub_u32 v210, v210, v9
    v_cmp_le_u32 s[66:67], 64, v3
    v_subrev_u32_e64 v9, 64, v3
    v_mfma_f32_32x32x16_bf16 v[144:159], v[52:55], a[96:99], v[144:159]
    ds_read_b64_tr_b16 v[78:79], v30 offset:25344
    ds_read_b64_tr_b16 v[80:81], v34 offset:24576
    v_lshlrev_b32 v9, 1, v9
    v_cndmask_b32 v3, v3, v9, s[66:67]
    v_and_b32 v212, 31, v3
    v_lshrrev_b32_e64 v213, 5, v3
    v_cmp_le_u32 s[76:77], 16, v210
    v_mfma_f32_32x32x16_bf16 v[160:175], v[56:59], a[96:99], v[160:175]
    ds_read_b64_tr_b16 v[82:83], v34 offset:25344
    v_subrev_u32 v9, 16, v210
    v_lshlrev_b32 v9, 1, v9
    v_cndmask_b32 v210, v210, v9, s[76:77]
    v_and_b32 v214, 7, v210
    s_waitcnt lgkmcnt(7)
    v_mfma_f32_32x32x16_bf16 v[176:191], a[100:103], a[100:103], v[176:191]
    ds_read_b128 a[108:111], v23 offset:32768
    ds_read_b64_tr_b16 v[48:49], v27 offset:24576
    s_mov_b64 exec, s[62:63]
    buffer_load_dwordx4 v16, s[8:11], s45 offen offset:2048 lds
    s_mov_b64 exec, -1
    s_add_u32 s44, s44, 128
    s_add_u32 s45, s45, 245760
    s_cmp_eq_u32 s44, s40
    s_cselect_b32 s44, s42, s44
    s_cselect_b32 s45, s43, s45
    v_add_u32 v214, 32, v214
    v_lshrrev_b32_e64 v215, 3, v210
    v_cmp_le_u32 vcc, 192, v0
    v_mfma_f32_32x32x16_bf16 v[128:143], v[60:63], a[100:103], v[128:143]
    ds_read_b64_tr_b16 v[50:51], v27 offset:25344
    ds_read_b64_tr_b16 v[52:53], v31 offset:24576
    v_cndmask_b32 v212, v212, v214, vcc
    v_cndmask_b32 v213, v213, v215, vcc
    v_cndmask_b32_e64 v8, v8, v211, vcc
    v_mfma_f32_32x32x16_bf16 v[144:159], v[64:67], a[100:103], v[144:159]
    ds_read_b64_tr_b16 v[54:55], v31 offset:25344
    ds_read_b64_tr_b16 v[56:57], v35 offset:24576
    s_and_b64 s[76:77], s[76:77], vcc
    s_andn2_b64 s[66:67], s[66:67], vcc
    s_or_b64 s[66:67], s[66:67], s[76:77]
    v_mul_u32_u24 v8, 2560, v8
    v_mfma_f32_32x32x16_bf16 v[160:175], v[68:71], a[100:103], v[160:175]
    ds_read_b64_tr_b16 v[58:59], v35 offset:25344
    v_lshl_add_u32 v8, v212, 6, v8
    v_lshl_add_u32 v8, v213, 3, v8
    v_add_u32 v8, 4096, v8
    s_waitcnt lgkmcnt(7) vmcnt(7)
    s_barrier
    v_mfma_f32_32x32x16_bf16 v[176:191], a[104:107], a[104:107], v[176:191]
    ds_read_b128 a[112:115], v20 offset:49152
    ds_read_b64_tr_b16 v[60:61], v24 offset:36864
    s_add_u32 m0, s46, 16384
    s_nop 0
    buffer_load_dwordx4 v10, s[4:7], s44 offen offset:0 lds
    buffer_load_dwordx4 v11, s[4:7], s44 offen offset:1024 lds
    v_add_u32_e64 v9, 32, v8
    v_cndmask_b32 v3, v8, v9, s[66:67]
    v_mfma_f32_32x32x16_bf16 v[128:143], v[72:75], a[104:107], v[128:143]
    ds_read_b64_tr_b16 v[62:63], v24 offset:37632
    ds_read_b64_tr_b16 v[64:65], v28 offset:36864
    v_mov_b32 v8, 16
    v_mov_b32 v9, 64
    v_cndmask_b32 v8, v8, v9, s[66:67]
    v_cmp_le_u32 vcc, 240, v0
    v_mfma_f32_32x32x16_bf16 v[144:159], v[76:79], a[104:107], v[144:159]
    ds_read_b64_tr_b16 v[66:67], v28 offset:37632
    ds_read_b64_tr_b16 v[68:69], v32 offset:36864
    v_mov_b32 v9, 11904
    v_cndmask_b32 v3, v3, v9, vcc
    v_accvgpr_write_b32 a168, v3
    v_add_u32 v3, v3, v8
    v_mfma_f32_32x32x16_bf16 v[160:175], v[80:83], a[104:107], v[160:175]
    ds_read_b64_tr_b16 v[70:71], v32 offset:37632
    v_accvgpr_write_b32 a169, v3
    v_lshlrev_b32 v3, 4, v0
    v_mov_b32 v9, 1073741824
    s_waitcnt lgkmcnt(7)
    v_mfma_f32_32x32x16_bf16 v[176:191], a[108:111], a[108:111], v[176:191]
    ds_read_b128 a[116:119], v21 offset:49152
    ds_read_b64_tr_b16 v[72:73], v25 offset:36864
    buffer_load_dwordx4 v12, s[4:7], s44 offen offset:2048 lds
    buffer_load_dwordx4 v13, s[4:7], s44 offen offset:3072 lds
    v_cndmask_b32 v3, v3, v9, vcc
    v_accvgpr_write_b32 a170, v3
    v_mfma_f32_32x32x16_bf16 v[128:143], v[48:51], a[108:111], v[128:143]
    ds_read_b64_tr_b16 v[74:75], v25 offset:37632
    ds_read_b64_tr_b16 v[76:77], v29 offset:36864
    v_lshrrev_b32 v2, 5, v1
    v_and_b32 v3, 1, v1
    v_cmp_eq_u32 vcc, v2, v3
    v_bfe_u32 v4, v1, 4, 1
    v_mfma_f32_32x32x16_bf16 v[144:159], v[52:55], a[108:111], v[144:159]
    ds_read_b64_tr_b16 v[78:79], v29 offset:37632
    ds_read_b64_tr_b16 v[80:81], v33 offset:36864
    v_bfe_u32 v5, v1, 1, 1
    v_lshl_or_b32 v4, v4, 1, v5
    v_bfe_u32 v7, v1, 2, 2
    v_mul_u32_u24 v8, 960, v2
    v_mfma_f32_32x32x16_bf16 v[160:175], v[56:59], a[108:111], v[160:175]
    ds_read_b64_tr_b16 v[82:83], v33 offset:37632
    v_mul_u32_u24 v9, 40, v7
    v_add_u32 v8, v8, v9
    v_lshl_add_u32 v8, v4, 3, v8
    v_add_u32 v8, 2048, v8
    s_waitcnt lgkmcnt(7)
    v_mfma_f32_32x32x16_bf16 v[176:191], a[112:115], a[112:115], v[176:191]
    ds_read_b128 a[120:123], v22 offset:49152
    ds_read_b64_tr_b16 v[48:49], v26 offset:36864
    v_mfma_f32_16x16x32_bf16 v[192:195], v[44:47], v[60:63], v[192:195]
    v_mfma_f32_16x16x32_bf16 v[196:199], v[44:47], v[64:67], v[196:199]
    v_mfma_f32_16x16x32_bf16 v[200:203], v[44:47], v[68:71], v[200:203]
    s_add_u32 m0, s47, 12288
    s_mov_b64 exec, s[58:59]
    buffer_load_dwordx4 v14, s[8:11], s45 offen offset:0 lds
    s_mov_b64 exec, -1
    s_mov_b64 exec, s[60:61]
    buffer_load_dwordx4 v15, s[8:11], s45 offen offset:1024 lds
    s_mov_b64 exec, -1
    v_mfma_f32_32x32x16_bf16 v[128:143], v[60:63], a[112:115], v[128:143]
    ds_read_b64_tr_b16 v[50:51], v26 offset:37632
    ds_read_b64_tr_b16 v[52:53], v30 offset:36864
    v_mov_b32 v9, 1024
    v_cndmask_b32 v121, v9, v8, vcc
    v_add_u32 v8, 4096, v8
    v_cndmask_b32 v8, v9, v8, vcc
    v_mfma_f32_32x32x16_bf16 v[144:159], v[64:67], a[112:115], v[144:159]
    ds_read_b64_tr_b16 v[54:55], v30 offset:37632
    ds_read_b64_tr_b16 v[56:57], v34 offset:36864
    v_accvgpr_write_b32 a171, v8
    v_mul_u32_u24 v2, 2560, v2
    v_lshl_add_u32 v2, v7, 6, v2
    v_add_u32 v2, 4096, v2
    v_add_u32_e64 v5, v4, v3
    v_mfma_f32_32x32x16_bf16 v[160:175], v[68:71], a[112:115], v[160:175]
    ds_read_b64_tr_b16 v[58:59], v34 offset:37632
    v_lshl_add_u32 v5, v5, 3, v2
    v_add_u32 v6, 4, v4
    v_cmp_eq_u32 s[66:67], 0, v4
    v_lshlrev_b32 v3, 2, v3
    s_waitcnt lgkmcnt(7)
    v_mfma_f32_32x32x16_bf16 v[176:191], a[116:119], a[116:119], v[176:191]
    ds_read_b128 a[124:127], v23 offset:49152
    ds_read_b64_tr_b16 v[60:61], v27 offset:36864
    s_mov_b64 exec, s[62:63]
    buffer_load_dwordx4 v16, s[8:11], s45 offen offset:2048 lds
    s_mov_b64 exec, -1
    v_cndmask_b32 v3, 0, v3, s[66:67]
    v_sub_u32 v6, v6, v3
    v_lshl_add_u32 v6, v6, 3, v2
    v_mfma_f32_32x32x16_bf16 v[128:143], v[72:75], a[116:119], v[128:143]
    ds_read_b64_tr_b16 v[62:63], v27 offset:37632
    ds_read_b64_tr_b16 v[64:65], v31 offset:36864
    v_mov_b32 v3, 9216
    v_cndmask_b32_e64 v5, v3, v5, vcc
    v_accvgpr_write_b32 a172, v5
    v_mfma_f32_32x32x16_bf16 v[144:159], v[76:79], a[116:119], v[144:159]
    ds_read_b64_tr_b16 v[66:67], v31 offset:37632
    ds_read_b64_tr_b16 v[68:69], v35 offset:36864
    v_cndmask_b32_e64 v6, v3, v6, vcc
    v_accvgpr_write_b32 a173, v6
    ds_read_b64_tr_b16 v[84:85], v121 offset:0
    ds_read_b64_tr_b16 v[86:87], v121 offset:160
    v_mfma_f32_32x32x16_bf16 v[160:175], v[80:83], a[116:119], v[160:175]
    ds_read_b64_tr_b16 v[70:71], v35 offset:37632
    ds_read_b64_tr_b16 v[88:89], v121 offset:32
    ds_read_b64_tr_b16 v[90:91], v121 offset:192
    ds_read_b64_tr_b16 v[92:93], v121 offset:320
    s_waitcnt lgkmcnt(12) vmcnt(7)
    s_barrier
    v_mfma_f32_32x32x16_bf16 v[176:191], a[120:123], a[120:123], v[176:191]
    ds_read_b128 a[128:131], v20 offset:0
    ds_read_b64_tr_b16 v[72:73], v24 offset:0
    s_add_u32 m0, s96, 16384
    s_nop 0
    buffer_load_dwordx4 v218, s[20:23], s72 offen lds
    s_add_u32 s72, s72, 98304
    s_add_u32 m0, s48, 114688
    s_nop 0
    buffer_load_dwordx4 v17, s[8:11], s41 offen offset:0 lds
    buffer_load_dwordx2 v[216:217], off, s[32:35], 0 sc1
    ds_read_b64_tr_b16 v[94:95], v121 offset:480
    v_mfma_f32_32x32x16_bf16 v[128:143], v[48:51], a[120:123], v[128:143]
    ds_read_b64_tr_b16 v[74:75], v24 offset:768
    ds_read_b64_tr_b16 v[76:77], v28 offset:0
    ds_read_b64_tr_b16 v[96:97], v121 offset:352
    ds_read_b64_tr_b16 v[98:99], v121 offset:512
    ds_read_b64_tr_b16 v[100:101], v121 offset:640
    ds_read_b64_tr_b16 v[102:103], v121 offset:800
    v_mfma_f32_32x32x16_bf16 v[144:159], v[52:55], a[120:123], v[144:159]
    ds_read_b64_tr_b16 v[78:79], v28 offset:768
    ds_read_b64_tr_b16 v[80:81], v32 offset:0
    ds_read_b64_tr_b16 v[104:105], v121 offset:672
    ds_read_b64_tr_b16 v[106:107], v121 offset:832
    v_lshrrev_b32_e64 v2, 1, v0
    v_and_b32 v2, 0x60, v2
    v_mfma_f32_32x32x16_bf16 v[160:175], v[56:59], a[120:123], v[160:175]
    ds_read_b64_tr_b16 v[82:83], v32 offset:768
    v_and_b32 v3, 31, v1
    v_or_b32 v2, v2, v3
    v_lshrrev_b32 v4, 5, v1
    v_lshlrev_b32 v5, 13, v4
    s_waitcnt lgkmcnt(15)
    v_mfma_f32_32x32x16_bf16 v[176:191], a[124:127], a[124:127], v[176:191]
    ds_read_b128 a[132:135], v21 offset:0
    ds_read_b64_tr_b16 v[48:49], v25 offset:0
    s_add_u32 m0, s48, 114688
    s_nop 0
    buffer_load_dwordx4 v18, s[8:11], s41 offen offset:1024 lds
    s_add_u32 s41, s41, 245760
    s_cmp_ge_u32 s41, 2457600
    s_cselect_b32 s41, s74, s41
    v_lshl_add_u32 v5, v2, 6, v5
    v_bfe_u32 v6, v2, 1, 3
    v_lshl_or_b32 v5, v6, 3, v5
    v_mfma_f32_32x32x16_bf16 v[128:143], v[60:63], a[124:127], v[128:143]
    ds_read_b64_tr_b16 v[50:51], v25 offset:768
    ds_read_b64_tr_b16 v[52:53], v29 offset:0
    v_add_u32 v5, 45056, v5
    v_sub_u32 v6, 16, v19
    v_xor_b32_e64 v122, v5, v6
    v_mfma_f32_32x32x16_bf16 v[144:159], v[64:67], a[124:127], v[144:159]
    ds_read_b64_tr_b16 v[54:55], v29 offset:768
    ds_read_b64_tr_b16 v[56:57], v33 offset:0
    v_xor_b32 v123, 24, v5
    v_xor_b32 v124, 32, v5
    v_lshlrev_b32 v6, 3, v4
    v_xor_b32 v125, v5, v6
    v_mfma_f32_32x32x16_bf16 v[160:175], v[68:71], a[124:127], v[160:175]
    ds_read_b64_tr_b16 v[58:59], v33 offset:768
    v_add_u32 v6, 8, v6
    v_xor_b32 v126, v5, v6
    v_lshlrev_b32 v5, 14, v4
    s_waitcnt lgkmcnt(7)
    v_mfma_f32_32x32x16_bf16 v[176:191], a[128:131], a[128:131], v[176:191]
    ds_read_b128 a[136:139], v22 offset:0
    ds_read_b64_tr_b16 v[60:61], v26 offset:0
    s_add_u32 m0, s96, 20480
    s_nop 0
    buffer_load_dwordx4 v218, s[20:23], s72 offen lds
    s_add_u32 s72, s72, 98304
    v_mfma_f32_16x16x32_bf16 v[192:195], v[44:47], v[72:75], v[192:195]
    v_mfma_f32_16x16x32_bf16 v[196:199], v[44:47], v[76:79], v[196:199]
    v_mfma_f32_16x16x32_bf16 v[200:203], v[44:47], v[80:83], v[200:203]
    s_add_u32 m0, s48, 122880
    s_nop 0
    buffer_load_dwordx4 v17, s[8:11], s41 offen offset:0 lds
    v_mfma_f32_32x32x16_bf16 v[128:143], v[72:75], a[128:131], v[128:143]
    ds_read_b64_tr_b16 v[62:63], v26 offset:768
    ds_read_b64_tr_b16 v[64:65], v30 offset:0
    v_lshl_add_u32 v5, v2, 7, v5
    v_bfe_u32 v6, v2, 1, 1
    v_lshl_or_b32 v5, v6, 6, v5
    v_bfe_u32 v6, v2, 2, 1
    v_lshl_or_b32 v5, v6, 5, v5
    v_mfma_f32_32x32x16_bf16 v[144:159], v[76:79], a[128:131], v[144:159]
    ds_read_b64_tr_b16 v[66:67], v30 offset:768
    ds_read_b64_tr_b16 v[68:69], v34 offset:0
    v_and_b32_e64 v6, 1, v2
    v_lshl_or_b32 v5, v6, 4, v5
    v_add_u32 v117, 61440, v5
    v_bfe_u32 v3, v1, 2, 2
    v_lshl_add_u32 v2, v4, 3, v3
    v_mfma_f32_32x32x16_bf16 v[160:175], v[80:83], a[128:131], v[160:175]
    ds_read_b64_tr_b16 v[70:71], v34 offset:768
    v_bfe_u32 v5, v1, 4, 1
    v_and_b32 v6, 3, v1
    v_lshl_add_u32 v5, v5, 2, v6
    v_lshrrev_b32 v6, 1, v2
    s_waitcnt lgkmcnt(7)
    v_mfma_f32_32x32x16_bf16 v[176:191], a[132:135], a[132:135], v[176:191]
    ds_read_b128 a[140:143], v23 offset:0
    ds_read_b64_tr_b16 v[72:73], v27 offset:0
    s_add_u32 m0, s48, 122880
    s_nop 0
    buffer_load_dwordx4 v18, s[8:11], s41 offen offset:1024 lds
    s_add_u32 s41, s41, 245760
    s_cmp_ge_u32 s41, 2457600
    s_cselect_b32 s41, s74, s41
    v_xor_b32 v7, v5, v6
    v_lshlrev_b32_e64 v7, 3, v7
    v_lshl_add_u32 v7, v2, 6, v7
    v_mfma_f32_32x32x16_bf16 v[128:143], v[48:51], a[132:135], v[128:143]
    ds_read_b64_tr_b16 v[74:75], v27 offset:768
    ds_read_b64_tr_b16 v[76:77], v31 offset:0
    s_and_b32 s49, s3, 1
    s_lshr_b32 s50, s3, 1
    s_lshl_b32 s51, s49, 13
    v_mfma_f32_32x32x16_bf16 v[144:159], v[52:55], a[132:135], v[144:159]
    ds_read_b64_tr_b16 v[78:79], v31 offset:768
    ds_read_b64_tr_b16 v[80:81], v35 offset:0
    s_add_u32 s51, s51, 45056
    v_add_u32 v108, s51, v7
    v_add_u32 v6, 2, v6
    v_xor_b32 v7, v5, v6
    v_mfma_f32_32x32x16_bf16 v[160:175], v[56:59], a[132:135], v[160:175]
    ds_read_b64_tr_b16 v[82:83], v35 offset:768
    v_lshlrev_b32 v7, 3, v7
    v_lshl_add_u32 v7, v2, 6, v7
    s_add_u32 s51, s51, 256
    s_waitcnt lgkmcnt(7) vmcnt(7)
    s_barrier
    v_mfma_f32_32x32x16_bf16 v[176:191], a[136:139], a[136:139], v[176:191]
    ds_read_b128 a[144:147], v20 offset:16384
    ds_read_b64_tr_b16 v[48:49], v24 offset:12288
    s_add_u32 m0, s96, 24576
    s_nop 0
    buffer_load_dwordx4 v218, s[20:23], s72 offen lds
    s_add_u32 s72, s72, 98304
    s_add_u32 m0, s48, 131072
    s_nop 0
    buffer_load_dwordx4 v17, s[8:11], s41 offen offset:0 lds
    v_add_u32 v109, s51, v7
    v_lshrrev_b32_e64 v6, 1, v5
    v_mfma_f32_32x32x16_bf16 v[128:143], v[60:63], a[136:139], v[128:143]
    ds_read_b64_tr_b16 v[50:51], v24 offset:13056
    ds_read_b64_tr_b16 v[52:53], v28 offset:12288
    s_lshl_b32 s51, s50, 2
    v_or_b32 v6, s51, v6
    v_lshrrev_b32 v7, 1, v3
    v_lshlrev_b32 v7, 2, v7
    v_mfma_f32_32x32x16_bf16 v[144:159], v[64:67], a[136:139], v[144:159]
    ds_read_b64_tr_b16 v[54:55], v28 offset:13056
    ds_read_b64_tr_b16 v[56:57], v32 offset:12288
    v_and_b32 v3, 1, v3
    v_or_b32 v7, v7, v3
    v_xor_b32 v6, v6, v7
    v_lshlrev_b32 v6, 4, v6
    v_mfma_f32_32x32x16_bf16 v[160:175], v[68:71], a[136:139], v[160:175]
    ds_read_b64_tr_b16 v[58:59], v32 offset:13056
    v_and_b32 v5, 1, v5
    v_lshl_or_b32 v6, v5, 3, v6
    v_lshl_add_u32 v6, v2, 7, v6
    s_waitcnt lgkmcnt(7)
    v_mfma_f32_32x32x16_bf16 v[176:191], a[140:143], a[140:143], v[176:191]
    ds_read_b128 a[148:151], v21 offset:16384
    ds_read_b64_tr_b16 v[60:61], v25 offset:12288
    s_add_u32 m0, s48, 131072
    s_nop 0
    buffer_load_dwordx4 v18, s[8:11], s41 offen offset:1024 lds
    s_add_u32 s41, s41, 245760
    s_cmp_ge_u32 s41, 2457600
    s_cselect_b32 s41, s74, s41
    s_lshl_b32 s51, s49, 14
    s_add_u32 s51, s51, 61440
    v_add_u32 v110, s51, v6
    v_mfma_f32_32x32x16_bf16 v[128:143], v[72:75], a[140:143], v[128:143]
    ds_read_b64_tr_b16 v[62:63], v25 offset:13056
    ds_read_b64_tr_b16 v[64:65], v29 offset:12288
    v_xor_b32 v6, 32, v6
    s_add_u32 s51, s51, 512
    v_add_u32 v111, s51, v6
    v_mfma_f32_32x32x16_bf16 v[144:159], v[76:79], a[140:143], v[144:159]
    ds_read_b64_tr_b16 v[66:67], v29 offset:13056
    ds_read_b64_tr_b16 v[68:69], v33 offset:12288
    s_lshl_b32 s51, s36, 12
    s_lshl_b32 s76, s37, 16
    s_add_u32 s76, s76, s51
    s_add_u32 s76, s76, 65536
    v_mfma_f32_32x32x16_bf16 v[160:175], v[80:83], a[140:143], v[160:175]
    ds_read_b64_tr_b16 v[70:71], v33 offset:13056
    s_mul_i32 s51, s49, 1536
    s_mul_i32 s52, s49, 384
    s_add_u32 s52, s52, 3072
    s_waitcnt lgkmcnt(7)
    v_mfma_f32_32x32x16_bf16 v[176:191], a[144:147], a[144:147], v[176:191]
    ds_read_b128 a[152:155], v22 offset:16384
    ds_read_b64_tr_b16 v[72:73], v26 offset:12288
    s_add_u32 m0, s96, 28672
    s_nop 0
    buffer_load_dwordx4 v218, s[20:23], s72 offen lds
    v_mfma_f32_16x16x32_bf16 v[192:195], v[44:47], v[48:51], v[192:195]
    v_mfma_f32_16x16x32_bf16 v[196:199], v[44:47], v[52:55], v[196:199]
    v_mfma_f32_16x16x32_bf16 v[200:203], v[44:47], v[56:59], v[200:203]
    s_cmp_eq_u32 s50, 0
    s_cselect_b32 s51, s51, s52
    s_cselect_b32 s52, 4, 1
    s_cselect_b32 s66, 32, 8
    v_mfma_f32_32x32x16_bf16 v[128:143], v[48:51], a[144:147], v[128:143]
    ds_read_b64_tr_b16 v[74:75], v26 offset:13056
    ds_read_b64_tr_b16 v[76:77], v30 offset:12288
    s_lshl_b32 s52, s52, 8
    s_add_u32 s76, s76, s51
    s_add_u32 s77, s76, s52
    v_and_b32_e64 v2, 31, v1
    v_mfma_f32_32x32x16_bf16 v[144:159], v[52:55], a[144:147], v[144:159]
    ds_read_b64_tr_b16 v[78:79], v30 offset:13056
    ds_read_b64_tr_b16 v[80:81], v34 offset:12288
    v_mul_u32_u24 v3, s66, v4
    v_add_u32 v3, v3, v2
    v_cmp_gt_u32 vcc, s66, v2
    v_lshlrev_b32 v4, 4, v3
    v_mfma_f32_32x32x16_bf16 v[160:175], v[56:59], a[144:147], v[160:175]
    ds_read_b64_tr_b16 v[82:83], v34 offset:13056
    v_lshlrev_b32 v5, 3, v3
    v_mov_b32 v6, 1073741824
    v_cndmask_b32 v118, v6, v4, vcc
    v_cndmask_b32 v119, v6, v5, vcc
    s_waitcnt lgkmcnt(7)
    v_mfma_f32_32x32x16_bf16 v[176:191], a[148:151], a[148:151], v[176:191]
    ds_read_b128 a[156:159], v23 offset:16384
    ds_read_b64_tr_b16 v[48:49], v27 offset:12288
    s_add_u32 m0, s48, 139264
    s_nop 0
    buffer_load_dwordx4 v17, s[8:11], s41 offen offset:0 lds
    v_mfma_f32_32x32x16_bf16 v[128:143], v[60:63], a[148:151], v[128:143]
    ds_read_b64_tr_b16 v[50:51], v27 offset:13056
    ds_read_b64_tr_b16 v[52:53], v31 offset:12288
    v_mfma_f32_32x32x16_bf16 v[144:159], v[64:67], a[148:151], v[144:159]
    ds_read_b64_tr_b16 v[54:55], v31 offset:13056
    ds_read_b64_tr_b16 v[56:57], v35 offset:12288
    v_lshlrev_b32 v204, 2, v1
    s_mul_i32 s53, s3, 384
    s_add_u32 s53, s53, 4096
    v_add_u32 v204, s53, v204
    s_mov_b64 exec, 0xffff
    ds_write2_b32 v204, v192, v193 offset0:0 offset1:16
    ds_write2_b32 v204, v196, v197 offset0:32 offset1:48
    ds_write2_b32 v204, v200, v201 offset0:64 offset1:80
    s_mov_b64 exec, -1
    v_mfma_f32_32x32x16_bf16 v[160:175], v[68:71], a[148:151], v[160:175]
    ds_read_b64_tr_b16 v[58:59], v35 offset:13056
    s_waitcnt lgkmcnt(1)
    s_barrier
    v_mfma_f32_32x32x16_bf16 v[176:191], a[152:155], a[152:155], v[176:191]
    s_add_u32 m0, s48, 139264
    s_nop 0
    buffer_load_dwordx4 v18, s[8:11], s41 offen offset:1024 lds
    s_add_u32 s41, s41, 245760
    s_cmp_ge_u32 s41, 2457600
    s_cselect_b32 s41, s74, s41
    v_min_u32 v204, 96, v0
    v_mfma_f32_32x32x16_bf16 v[128:143], v[72:75], a[152:155], v[128:143]
    v_lshlrev_b32 v204, 2, v204
    v_mfma_f32_32x32x16_bf16 v[144:159], v[76:79], a[152:155], v[144:159]
    ds_read_b32 v206, v204 offset:4096
    ds_read_b32 v207, v204 offset:4480
    ds_read_b32 v208, v204 offset:4864
    ds_read_b32 v209, v204 offset:5248
    v_mfma_f32_32x32x16_bf16 v[160:175], v[80:83], a[152:155], v[160:175]
    s_waitcnt vmcnt(10)
    v_cmp_eq_u32 vcc, 0, v217
    s_cbranch_vccnz Ls_2
Lb_3:
    v_readfirstlane_b32 s54, v216
    v_readfirstlane_b32 s55, v217
    s_mov_b32 s32, s100
    s_mov_b32 s33, s101
    s_mov_b32 s34, 1966080
    s_waitcnt lgkmcnt(4)
    v_mfma_f32_32x32x16_bf16 v[176:191], a[156:159], a[156:159], v[176:191]
    s_waitcnt lgkmcnt(0)
    v_add_f32 v206, v206, v207
    v_add_f32 v208, v208, v209
    v_add_f32_e64 v206, v206, v208
    ds_write_b32 v204, v206 offset:0
    v_mfma_f32_32x32x16_bf16 v[128:143], v[48:51], a[156:159], v[128:143]
    v_mfma_f32_32x32x16_bf16 v[144:159], v[52:55], a[156:159], v[144:159]
    s_lshl_b32 s49, s36, 4
    s_add_u32 s49, s49, s37
    s_lshl_b32 s49, s49, 7
    s_add_u32 s49, s49, 22085632
    s_and_b32 s50, s54, -16
    s_or_b32 s50, s50, s99
    v_lshlrev_b32 v220, 4, v1
    s_cmp_lg_u32 s3, 0
    s_cbranch_scc1 Lw0_5
    v_mov_b32 v216, s50
    v_mov_b32 v217, s55
    v_mov_b32 v218, s54
    v_mov_b32 v219, s55
    s_mov_b64 exec, 0xff
    buffer_store_dwordx4 v[216:219], v220, s[12:15], s49 offen sc1
    s_mov_b64 exec, -1
Lw0_5:
    v_mfma_f32_32x32x16_bf16 v[160:175], v[56:59], a[156:159], v[160:175]
    s_mov_b32 s66, 0xaaaaaaaa
    s_mov_b32 s67, 0xaaaaaaaa
    v_cndmask_b32 v176, v176, v177, s[66:67]
    v_cndmask_b32 v178, v178, v179, s[66:67]
    v_cndmask_b32 v180, v180, v181, s[66:67]
    v_cndmask_b32 v182, v182, v183, s[66:67]
    v_cndmask_b32 v184, v184, v185, s[66:67]
    v_cndmask_b32 v186, v186, v187, s[66:67]
    v_cndmask_b32 v188, v188, v189, s[66:67]
    v_cndmask_b32 v190, v190, v191, s[66:67]
    s_waitcnt lgkmcnt(0)
    s_barrier
    v_accvgpr_read_b32 v32, a161
    ds_read_b128 v[204:207], v19 offset:0
    s_mov_b32 s62, s41
    s_add_u32 s41, s41, 245760
    s_cmp_ge_u32 s41, 2457600
    s_cselect_b32 s41, s74, s41
    s_add_u32 s41, s41, 245760
    s_cmp_ge_u32 s41, 2457600
    s_cselect_b32 s41, s74, s41
    s_add_u32 m0, s48, 81920
    s_nop 0
    buffer_load_dwordx4 v17, s[8:11], s41 offen offset:0 lds
    s_mov_b32 s66, 0xcccccccc
    s_mov_b32 s67, 0xcccccccc
    v_cndmask_b32 v176, v176, v178, s[66:67]
    ds_read_b128 v[208:211], v19 offset:32
    v_cndmask_b32 v180, v180, v182, s[66:67]
    v_cndmask_b32 v184, v184, v186, s[66:67]
    v_cndmask_b32 v188, v188, v190, s[66:67]
    ds_read_b128 v[212:215], v19 offset:64
    s_mov_b32 s66, 0xff00ff00
    s_mov_b32 s67, 0xff00ff00
    v_cndmask_b32 v176, v176, v180, s[66:67]
    ds_read_b128 v[216:219], v19 offset:96
    v_cndmask_b32 v184, v184, v188, s[66:67]
    s_mov_b32 s66, 0xffff0000
    s_mov_b32 s67, 0xffff0000
    ds_read_b128 v[220:223], v19 offset:128
    v_cndmask_b32 v176, v176, v184, s[66:67]
    s_mov_b32 s66, 0xf0f0f0f
    s_mov_b32 s67, 0xf0f0f0f0
    ds_read_b128 v[224:227], v19 offset:160
    v_cndmask_b32 v176, 0, v176, s[66:67]
    v_mov_b32 v177, v176
    v_mul_f32 v75, 0xbacccccd, v168
    ds_read_b128 v[228:231], v19 offset:192
    v_mov_b32 v254, 0
    v_permlane32_swap_b32 v176, v177
    v_add_f32 v176, v176, v177
    s_add_u32 m0, s48, 81920
    s_nop 0
    buffer_load_dwordx4 v18, s[8:11], s41 offen offset:1024 lds
    s_add_u32 s41, s41, 245760
    s_cmp_ge_u32 s41, 2457600
    s_cselect_b32 s41, s74, s41
    ds_read_b128 v[232:235], v19 offset:224
    v_mul_f32 v176, 0x3acccccd, v176
    v_fma_f32 v176, -v75, v75, v176
    v_max_f32 v176, 0, v176
    ds_read_b128 v[236:239], v19 offset:256
    v_add_f32 v176, 0x3727c5ac, v176
    v_rsq_f32 v76, v176
    v_mov_b32 v255, 0
    ds_read_b128 v[240:243], v19 offset:288
    s_waitcnt lgkmcnt(9)
    v_pk_fma_f32 v[128:129], v[204:205], v[74:75], v[128:129] op_sel:[0,1,0] op_sel_hi:[1,1,1]
    v_pk_fma_f32 v[130:131], v[206:207], v[74:75], v[130:131] op_sel:[0,1,0] op_sel_hi:[1,1,1]
    v_cvt_pk_bf16_f32 v244, v128, v129
    v_cvt_pk_bf16_f32 v245, v130, v131
    s_waitcnt lgkmcnt(8)
    v_pk_fma_f32 v[132:133], v[208:209], v[74:75], v[132:133] op_sel:[0,1,0] op_sel_hi:[1,1,1]
    v_pk_fma_f32 v[134:135], v[210:211], v[74:75], v[134:135] op_sel:[0,1,0] op_sel_hi:[1,1,1]
    v_cvt_pk_bf16_f32 v246, v132, v133
    v_cvt_pk_bf16_f32 v247, v134, v135
    s_waitcnt lgkmcnt(7)
    v_pk_fma_f32 v[136:137], v[212:213], v[74:75], v[136:137] op_sel:[0,1,0] op_sel_hi:[1,1,1]
    v_pk_fma_f32 v[138:139], v[214:215], v[74:75], v[138:139] op_sel:[0,1,0] op_sel_hi:[1,1,1]
    v_cvt_pk_bf16_f32 v248, v136, v137
    v_cvt_pk_bf16_f32 v249, v138, v139
    s_waitcnt lgkmcnt(6)
    v_pk_fma_f32 v[140:141], v[216:217], v[74:75], v[140:141] op_sel:[0,1,0] op_sel_hi:[1,1,1]
    v_pk_fma_f32 v[142:143], v[218:219], v[74:75], v[142:143] op_sel:[0,1,0] op_sel_hi:[1,1,1]
    v_cvt_pk_bf16_f32 v250, v140, v141
    v_cvt_pk_bf16_f32 v251, v142, v143
    s_waitcnt lgkmcnt(5)
    v_pk_fma_f32 v[144:145], v[220:221], v[74:75], v[144:145] op_sel:[0,1,0] op_sel_hi:[1,1,1]
    v_pk_fma_f32 v[146:147], v[222:223], v[74:75], v[146:147] op_sel:[0,1,0] op_sel_hi:[1,1,1]
    s_add_u32 m0, s48, 90112
    s_nop 0
    buffer_load_dwordx4 v17, s[8:11], s41 offen offset:0 lds
    v_cvt_pk_bf16_f32 v252, v144, v145
    v_cvt_pk_bf16_f32 v253, v146, v147
    s_waitcnt lgkmcnt(0)
    v_pk_fma_f32 v[148:149], v[224:225], v[74:75], v[148:149] op_sel:[0,1,0] op_sel_hi:[1,1,1]
    v_pk_fma_f32 v[150:151], v[226:227], v[74:75], v[150:151] op_sel:[0,1,0] op_sel_hi:[1,1,1]
    v_pk_fma_f32 v[152:153], v[228:229], v[74:75], v[152:153] op_sel:[0,1,0] op_sel_hi:[1,1,1]
    v_pk_fma_f32 v[154:155], v[230:231], v[74:75], v[154:155] op_sel:[0,1,0] op_sel_hi:[1,1,1]
    v_pk_fma_f32 v[156:157], v[232:233], v[74:75], v[156:157] op_sel:[0,1,0] op_sel_hi:[1,1,1]
    v_pk_fma_f32 v[158:159], v[234:235], v[74:75], v[158:159] op_sel:[0,1,0] op_sel_hi:[1,1,1]
    v_pk_fma_f32 v[160:161], v[236:237], v[74:75], v[160:161] op_sel:[0,1,0] op_sel_hi:[1,1,1]
    v_pk_fma_f32 v[162:163], v[238:239], v[74:75], v[162:163] op_sel:[0,1,0] op_sel_hi:[1,1,1]
    v_pk_fma_f32 v[164:165], v[240:241], v[74:75], v[164:165] op_sel:[0,1,0] op_sel_hi:[1,1,1]
    v_pk_fma_f32 v[166:167], v[242:243], v[74:75], v[166:167] op_sel:[0,1,0] op_sel_hi:[1,1,1]
    v_mfma_f32_32x32x16_bf16 v[204:219], v[84:87], v[244:247], 0
    v_mul_f32 v148, v148, v76
    v_mul_f32 v149, v149, v76
    v_cvt_pk_bf16_f32 v178, v148, v149
    v_mul_f32 v150, v150, v76
    v_mul_f32 v151, v151, v76
    v_cvt_pk_bf16_f32 v179, v150, v151
    ds_write_b64 v122, v[178:179]
    v_mfma_f32_32x32x16_bf16 v[220:235], v[88:91], v[244:247], 0
    v_mul_f32 v152, v152, v76
    v_mul_f32 v153, v153, v76
    v_cvt_pk_bf16_f32 v180, v152, v153
    v_mul_f32 v154, v154, v76
    v_mul_f32 v155, v155, v76
    v_cvt_pk_bf16_f32 v181, v154, v155
    v_mfma_f32_32x32x16_bf16 v[204:219], v[92:95], v[248:251], v[204:219]
    s_add_u32 m0, s48, 90112
    s_nop 0
    buffer_load_dwordx4 v18, s[8:11], s41 offen offset:1024 lds
    s_add_u32 s41, s41, 245760
    s_cmp_ge_u32 s41, 2457600
    s_cselect_b32 s41, s74, s41
    ds_write_b64 v123, v[180:181]
    v_mul_f32 v156, v156, v76
    v_mul_f32 v157, v157, v76
    v_cvt_pk_bf16_f32 v182, v156, v157
    v_mul_f32 v158, v158, v76
    v_mul_f32 v159, v159, v76
    v_mfma_f32_32x32x16_bf16 v[220:235], v[96:99], v[248:251], v[220:235]
    v_cvt_pk_bf16_f32 v183, v158, v159
    ds_write_b64 v124, v[182:183]
    v_mul_f32 v160, v160, v76
    v_mul_f32 v161, v161, v76
    v_cvt_pk_bf16_f32 v184, v160, v161
    v_mul_f32 v162, v162, v76
    v_mul_f32 v163, v163, v76
    v_mfma_f32_32x32x16_bf16 v[204:219], v[100:103], v[252:255], v[204:219]
    v_cvt_pk_bf16_f32 v185, v162, v163
    ds_write_b64 v125, v[184:185]
    v_mul_f32 v164, v164, v76
    v_mul_f32 v165, v165, v76
    v_cvt_pk_bf16_f32 v186, v164, v165
    v_mul_f32 v166, v166, v76
    v_mfma_f32_32x32x16_bf16 v[220:235], v[104:107], v[252:255], v[220:235]
    v_mul_f32 v167, v167, v76
    v_cvt_pk_bf16_f32 v187, v166, v167
    ds_write_b64 v126, v[186:187]
    v_mov_b32 v8, 0x3f80
    s_add_u32 m0, s48, 98304
    s_nop 0
    buffer_load_dwordx4 v17, s[8:11], s41 offen offset:0 lds
    v_xor_b32 v9, 48, v123
    ds_write_b32 v9, v8
    v_mul_f32 v8, 0x3fb8aa3b, v76
    v_max3_f32 v2, v204, v205, v206
    v_min3_f32 v3, v204, v205, v206
    v_max3_f32 v4, v207, v208, v209
    v_min3_f32 v5, v207, v208, v209
    v_max3_f32 v2, v210, v211, v2
    v_min3_f32 v3, v210, v211, v3
    v_max3_f32 v4, v212, v213, v4
    v_min3_f32 v5, v212, v213, v5
    v_max3_f32 v2, v214, v215, v2
    v_min3_f32 v3, v214, v215, v3
    v_max3_f32 v4, v216, v217, v4
    v_min3_f32 v5, v216, v217, v5
    v_max3_f32 v2, v218, v219, v2
    v_min3_f32 v3, v218, v219, v3
    v_max3_f32 v4, v220, v221, v4
    v_min3_f32 v5, v220, v221, v5
    v_max3_f32 v2, v222, v223, v2
    v_min3_f32 v3, v222, v223, v3
    v_max_f32 v2, v2, v4
    v_min_f32 v3, v3, v5
    v_pk_mul_f32 v[6:7], v[2:3], v[8:9] op_sel_hi:[1,0]
    v_pk_fma_f32 v[128:129], v[204:205], v[8:9], v[6:7] op_sel_hi:[1,0,0] neg_lo:[0,0,1] neg_hi:[0,0,1]
    v_pk_fma_f32 v[148:149], v[204:205], v[8:9], v[6:7] op_sel:[0,0,1] op_sel_hi:[1,0,1] neg_lo:[1,0,0] neg_hi:[1,0,0]
    v_pk_fma_f32 v[130:131], v[206:207], v[8:9], v[6:7] op_sel_hi:[1,0,0] neg_lo:[0,0,1] neg_hi:[0,0,1]
    v_pk_fma_f32 v[150:151], v[206:207], v[8:9], v[6:7] op_sel:[0,0,1] op_sel_hi:[1,0,1] neg_lo:[1,0,0] neg_hi:[1,0,0]
    v_pk_fma_f32 v[132:133], v[208:209], v[8:9], v[6:7] op_sel_hi:[1,0,0] neg_lo:[0,0,1] neg_hi:[0,0,1]
    v_pk_fma_f32 v[152:153], v[208:209], v[8:9], v[6:7] op_sel:[0,0,1] op_sel_hi:[1,0,1] neg_lo:[1,0,0] neg_hi:[1,0,0]
    s_add_u32 m0, s48, 98304
    s_nop 0
    buffer_load_dwordx4 v18, s[8:11], s41 offen offset:1024 lds
    s_add_u32 s41, s41, 245760
    s_cmp_ge_u32 s41, 2457600
    s_cselect_b32 s41, s74, s41
    v_pk_fma_f32 v[134:135], v[210:211], v[8:9], v[6:7] op_sel_hi:[1,0,0] neg_lo:[0,0,1] neg_hi:[0,0,1]
    v_pk_fma_f32 v[154:155], v[210:211], v[8:9], v[6:7] op_sel:[0,0,1] op_sel_hi:[1,0,1] neg_lo:[1,0,0] neg_hi:[1,0,0]
    v_pk_fma_f32 v[136:137], v[212:213], v[8:9], v[6:7] op_sel_hi:[1,0,0] neg_lo:[0,0,1] neg_hi:[0,0,1]
    v_pk_fma_f32 v[156:157], v[212:213], v[8:9], v[6:7] op_sel:[0,0,1] op_sel_hi:[1,0,1] neg_lo:[1,0,0] neg_hi:[1,0,0]
    v_pk_fma_f32 v[138:139], v[214:215], v[8:9], v[6:7] op_sel_hi:[1,0,0] neg_lo:[0,0,1] neg_hi:[0,0,1]
    v_pk_fma_f32 v[158:159], v[214:215], v[8:9], v[6:7] op_sel:[0,0,1] op_sel_hi:[1,0,1] neg_lo:[1,0,0] neg_hi:[1,0,0]
    v_pk_fma_f32 v[140:141], v[216:217], v[8:9], v[6:7] op_sel_hi:[1,0,0] neg_lo:[0,0,1] neg_hi:[0,0,1]
    v_pk_fma_f32 v[160:161], v[216:217], v[8:9], v[6:7] op_sel:[0,0,1] op_sel_hi:[1,0,1] neg_lo:[1,0,0] neg_hi:[1,0,0]
    v_pk_fma_f32 v[142:143], v[218:219], v[8:9], v[6:7] op_sel_hi:[1,0,0] neg_lo:[0,0,1] neg_hi:[0,0,1]
    v_pk_fma_f32 v[162:163], v[218:219], v[8:9], v[6:7] op_sel:[0,0,1] op_sel_hi:[1,0,1] neg_lo:[1,0,0] neg_hi:[1,0,0]
    v_pk_fma_f32 v[144:145], v[220:221], v[8:9], v[6:7] op_sel_hi:[1,0,0] neg_lo:[0,0,1] neg_hi:[0,0,1]
    v_pk_fma_f32 v[164:165], v[220:221], v[8:9], v[6:7] op_sel:[0,0,1] op_sel_hi:[1,0,1] neg_lo:[1,0,0] neg_hi:[1,0,0]
    v_pk_fma_f32 v[146:147], v[222:223], v[8:9], v[6:7] op_sel_hi:[1,0,0] neg_lo:[0,0,1] neg_hi:[0,0,1]
    v_pk_fma_f32 v[166:167], v[222:223], v[8:9], v[6:7] op_sel:[0,0,1] op_sel_hi:[1,0,1] neg_lo:[1,0,0] neg_hi:[1,0,0]
    v_exp_f32 v128, v128
    v_exp_f32 v148, v148
    v_exp_f32 v129, v129
    v_exp_f32 v149, v149
    v_exp_f32 v130, v130
    v_exp_f32 v150, v150
    v_exp_f32 v131, v131
    v_exp_f32 v151, v151
    s_add_u32 m0, s48, 106496
    s_nop 0
    buffer_load_dwordx4 v17, s[8:11], s41 offen offset:0 lds
    v_exp_f32 v132, v132
    v_exp_f32 v152, v152
    v_exp_f32 v133, v133
    v_exp_f32 v153, v153
    v_exp_f32 v134, v134
    v_exp_f32 v154, v154
    v_exp_f32 v135, v135
    v_exp_f32 v155, v155
    v_exp_f32 v136, v136
    v_exp_f32 v156, v156
    v_exp_f32 v137, v137
    v_exp_f32 v157, v157
    v_exp_f32 v138, v138
    v_exp_f32 v158, v158
    v_exp_f32 v139, v139
    s_add_u32 m0, s48, 106496
    s_nop 0
    buffer_load_dwordx4 v18, s[8:11], s41 offen offset:1024 lds
    v_exp_f32 v159, v159
    v_exp_f32 v140, v140
    v_exp_f32 v160, v160
    v_exp_f32 v141, v141
    v_exp_f32 v161, v161
    v_exp_f32 v142, v142
    v_exp_f32 v162, v162
    v_exp_f32 v143, v143
    v_exp_f32 v163, v163
    v_exp_f32 v144, v144
    v_exp_f32 v164, v164
    v_exp_f32 v145, v145
    v_exp_f32 v165, v165
    v_exp_f32 v146, v146
    v_exp_f32 v166, v166
    s_add_u32 m0, s96, 8192
    s_nop 0
    buffer_load_dwordx4 v32, s[16:19], s56 offen lds
    v_exp_f32 v147, v147
    v_exp_f32_e64 v167, v167
    v_pk_add_f32 v[2:3], v[128:129], v[130:131]
    v_pk_add_f32 v[4:5], v[148:149], v[150:151]
    v_pk_add_f32 v[2:3], v[2:3], v[132:133]
    v_pk_add_f32 v[4:5], v[4:5], v[152:153]
    v_pk_add_f32 v[2:3], v[2:3], v[134:135]
    v_pk_add_f32 v[4:5], v[4:5], v[154:155]
    v_pk_add_f32 v[2:3], v[2:3], v[136:137]
    v_pk_add_f32 v[4:5], v[4:5], v[156:157]
    v_pk_add_f32 v[2:3], v[2:3], v[138:139]
    v_pk_add_f32 v[4:5], v[4:5], v[158:159]
    v_pk_add_f32 v[2:3], v[2:3], v[140:141]
    v_pk_add_f32 v[4:5], v[4:5], v[160:161]
    v_pk_add_f32 v[2:3], v[2:3], v[142:143]
    v_pk_add_f32 v[4:5], v[4:5], v[162:163]
    v_pk_add_f32 v[2:3], v[2:3], v[144:145]
    v_pk_add_f32 v[4:5], v[4:5], v[164:165]
    v_pk_add_f32 v[2:3], v[2:3], v[146:147]
    v_pk_add_f32 v[4:5], v[4:5], v[166:167]
    v_add_f32 v2, v2, v3
    v_add_f32 v4, v4, v5
    v_rcp_f32 v2, v2
    v_rcp_f32 v4, v4
    v_pk_mul_f32 v[128:129], v[128:129], v[2:3] op_sel_hi:[1,0]
    v_pk_mul_f32 v[130:131], v[130:131], v[2:3] op_sel_hi:[1,0]
    v_cvt_pk_bf16_f32 v236, v128, v129
    s_add_u32 m0, s96, 0
    s_nop 0
    buffer_load_dwordx4 v32, s[28:31], s70 offen lds
    s_add_u32 s70, s70, 40960
    v_cvt_pk_bf16_f32 v237, v130, v131
    v_pk_mul_f32 v[132:133], v[132:133], v[2:3] op_sel_hi:[1,0]
    v_pk_mul_f32 v[134:135], v[134:135], v[2:3] op_sel_hi:[1,0]
    v_cvt_pk_bf16_f32 v238, v132, v133
    v_cvt_pk_bf16_f32 v239, v134, v135
    ds_write_b128 v117, v[236:239]
    v_pk_mul_f32 v[136:137], v[136:137], v[2:3] op_sel_hi:[1,0]
    v_pk_mul_f32 v[138:139], v[138:139], v[2:3] op_sel_hi:[1,0]
    v_cvt_pk_bf16_f32 v240, v136, v137
    v_cvt_pk_bf16_f32 v241, v138, v139
    v_pk_mul_f32 v[140:141], v[140:141], v[2:3] op_sel_hi:[1,0]
    v_pk_mul_f32 v[142:143], v[142:143], v[2:3] op_sel_hi:[1,0]
    v_cvt_pk_bf16_f32 v242, v140, v141
    v_cvt_pk_bf16_f32 v243, v142, v143
    v_xor_b32_e64 v9, 16, v117
    ds_write_b128 v9, v[240:243]
    v_pk_mul_f32 v[144:145], v[144:145], v[2:3] op_sel_hi:[1,0]
    v_pk_mul_f32 v[146:147], v[146:147], v[2:3] op_sel_hi:[1,0]
    v_cvt_pk_bf16_f32 v244, v144, v145
    v_cvt_pk_bf16_f32 v245, v146, v147
    v_pk_mul_f32 v[148:149], v[148:149], v[4:5] op_sel_hi:[1,0]
    v_pk_mul_f32 v[150:151], v[150:151], v[4:5] op_sel_hi:[1,0]
    v_cvt_pk_bf16_f32 v246, v148, v149
    v_cvt_pk_bf16_f32 v247, v150, v151
    v_xor_b32_e64 v9, 32, v117
    ds_write_b128 v9, v[244:247]
    v_pk_mul_f32 v[152:153], v[152:153], v[4:5] op_sel_hi:[1,0]
    v_pk_mul_f32 v[154:155], v[154:155], v[4:5] op_sel_hi:[1,0]
    v_cvt_pk_bf16_f32 v248, v152, v153
    v_cvt_pk_bf16_f32 v249, v154, v155
    s_add_u32 m0, s96, 4096
    s_nop 0
    buffer_load_dwordx4 v32, s[28:31], s70 offen lds
    v_pk_mul_f32 v[156:157], v[156:157], v[4:5] op_sel_hi:[1,0]
    v_pk_mul_f32 v[158:159], v[158:159], v[4:5] op_sel_hi:[1,0]
    v_cvt_pk_bf16_f32 v250, v156, v157
    v_cvt_pk_bf16_f32 v251, v158, v159
    v_xor_b32 v9, 48, v117
    ds_write_b128 v9, v[248:251]
    v_pk_mul_f32 v[160:161], v[160:161], v[4:5] op_sel_hi:[1,0]
    v_pk_mul_f32 v[162:163], v[162:163], v[4:5] op_sel_hi:[1,0]
    v_cvt_pk_bf16_f32 v252, v160, v161
    v_cvt_pk_bf16_f32 v253, v162, v163
    v_pk_mul_f32 v[164:165], v[164:165], v[4:5] op_sel_hi:[1,0]
    v_pk_mul_f32 v[166:167], v[166:167], v[4:5] op_sel_hi:[1,0]
    v_cvt_pk_bf16_f32 v254, v164, v165
    v_cvt_pk_bf16_f32 v255, v166, v167
    v_xor_b32 v9, 64, v117
    ds_write_b128 v9, v[252:255]
    s_waitcnt lgkmcnt(0)
    s_barrier
    ds_read_b64_tr_b16 v[128:129], v108 offset:0
    ds_read_b64_tr_b16 v[130:131], v109 offset:0
    ds_read_b64_tr_b16 v[160:161], v110 offset:0
    ds_read_b64_tr_b16 v[162:163], v111 offset:0
    ds_read_b64_tr_b16 v[132:133], v108 offset:1024
    ds_read_b64_tr_b16 v[134:135], v109 offset:1024
    ds_read_b64_tr_b16 v[164:165], v110 offset:2048
    ds_read_b64_tr_b16 v[166:167], v111 offset:2048
    ds_read_b64_tr_b16 v[136:137], v108 offset:2048
    ds_read_b64_tr_b16 v[138:139], v109 offset:2048
    ds_read_b64_tr_b16 v[168:169], v110 offset:4096
    ds_read_b64_tr_b16 v[170:171], v111 offset:4096
    s_waitcnt lgkmcnt(8)
    v_mfma_f32_32x32x16_bf16 v[204:219], v[128:131], v[160:163], 0
    ds_read_b64_tr_b16 v[140:141], v108 offset:3072
    ds_read_b64_tr_b16 v[142:143], v109 offset:3072
    ds_read_b64_tr_b16 v[172:173], v110 offset:6144
    ds_read_b64_tr_b16 v[174:175], v111 offset:6144
    s_waitcnt lgkmcnt(8)
    v_mfma_f32_32x32x16_bf16 v[204:219], v[132:135], v[164:167], v[204:219]
    ds_read_b64_tr_b16 v[144:145], v108 offset:4096
    ds_read_b64_tr_b16 v[146:147], v109 offset:4096
    ds_read_b64_tr_b16 v[176:177], v110 offset:8192
    ds_read_b64_tr_b16 v[178:179], v111 offset:8192
    s_waitcnt lgkmcnt(8)
    v_mfma_f32_32x32x16_bf16 v[204:219], v[136:139], v[168:171], v[204:219]
    ds_read_b64_tr_b16 v[148:149], v108 offset:5120
    ds_read_b64_tr_b16 v[150:151], v109 offset:5120
    ds_read_b64_tr_b16 v[180:181], v110 offset:10240
    ds_read_b64_tr_b16 v[182:183], v111 offset:10240
    s_waitcnt lgkmcnt(8)
    v_mfma_f32_32x32x16_bf16 v[204:219], v[140:143], v[172:175], v[204:219]
    ds_read_b64_tr_b16 v[152:153], v108 offset:6144
    ds_read_b64_tr_b16 v[154:155], v109 offset:6144
    ds_read_b64_tr_b16 v[184:185], v110 offset:12288
    ds_read_b64_tr_b16 v[186:187], v111 offset:12288
    s_waitcnt lgkmcnt(8)
    v_mfma_f32_32x32x16_bf16 v[204:219], v[144:147], v[176:179], v[204:219]
    ds_read_b64_tr_b16 v[156:157], v108 offset:7168
    ds_read_b64_tr_b16 v[158:159], v109 offset:7168
    ds_read_b64_tr_b16 v[188:189], v110 offset:14336
    ds_read_b64_tr_b16 v[190:191], v111 offset:14336
    s_waitcnt lgkmcnt(8)
    v_mfma_f32_32x32x16_bf16 v[204:219], v[148:151], v[180:183], v[204:219]
    s_lshl_b32 s60, s2, 2
    s_add_u32 s60, s60, 2048
    v_accvgpr_read_b32 v7, a167
    v_accvgpr_read_b32 v13, a162
    v_accvgpr_read_b32 v33, a163
    v_lshlrev_b32 v16, 4, v1
    v_accvgpr_read_b32 v35, a248
    v_accvgpr_read_b32 v14, a245
    s_waitcnt lgkmcnt(4)
    v_mfma_f32_32x32x16_bf16 v[204:219], v[152:155], v[184:187], v[204:219]
    v_accvgpr_read_b32 v15, a246
    v_accvgpr_read_b32 v81, a165
    v_accvgpr_read_b32 v82, a164
    v_accvgpr_read_b32 v72, a168
    v_accvgpr_read_b32 v73, a169
    v_accvgpr_read_b32 v80, a170
    v_accvgpr_read_b32 v78, a172
    v_accvgpr_read_b32 v79, a173
    s_waitcnt lgkmcnt(0)
    v_mfma_f32_32x32x16_bf16 v[204:219], v[156:159], v[188:191], v[204:219]
    v_accvgpr_read_b32 v10, a252
    v_accvgpr_read_b32 v11, a253
    v_accvgpr_read_b32 v12, a254
    s_waitcnt vmcnt(20)
    s_barrier
    ds_read_b64_tr_b16 v[48:49], v36 offset:16384
    ds_read_b64_tr_b16 v[50:51], v36 offset:16896
    ds_read_b64_tr_b16 v[52:53], v40 offset:16384
    ds_read_b64_tr_b16 v[54:55], v40 offset:16896
    ds_read_b64_tr_b16 v[56:57], v37 offset:16384
    ds_read_b64_tr_b16 v[58:59], v37 offset:16896
    ds_read_b64_tr_b16 v[60:61], v41 offset:16384
    ds_read_b64_tr_b16 v[62:63], v41 offset:16896
    v_cvt_pk_bf16_f32 v220, v204, v205
    v_cvt_pk_bf16_f32 v221, v206, v207
    v_cvt_pk_bf16_f32 v222, v208, v209
    v_cvt_pk_bf16_f32 v223, v210, v211
    v_cvt_pk_bf16_f32 v224, v212, v213
    v_cvt_pk_bf16_f32 v225, v214, v215
    buffer_store_dwordx4 v[220:223], v118, s[12:15], s76 offen sc1
    buffer_store_dwordx2 v[224:225], v119, s[12:15], s77 offen sc1
    s_waitcnt lgkmcnt(4)
    v_mfma_f32_32x32x16_bf16 v[128:143], v[48:51], a[0:3], 0
    ds_read_b64_tr_b16 v[64:65], v38 offset:16384
    ds_read_b64_tr_b16 v[66:67], v38 offset:16896
    v_mfma_f32_16x16x32_bf16 v[192:195], v[44:47], v[48:51], 0
    v_mfma_f32_16x16x32_bf16 v[196:199], v[44:47], v[52:55], 0
    s_mov_b32 s41, s62
    s_add_u32 m0, s48, 32768
    s_nop 0
    buffer_load_dwordx4 v17, s[8:11], s41 offen offset:0 lds
    v_mfma_f32_32x32x16_bf16 v[144:159], v[52:55], a[0:3], 0
    ds_read_b64_tr_b16 v[68:69], v42 offset:16384
    ds_read_b64_tr_b16 v[70:71], v42 offset:16896
    s_add_u32 m0, s48, 32768
    s_nop 0
    buffer_load_dwordx4 v18, s[8:11], s41 offen offset:1024 lds
    s_add_u32 s41, s41, 245760
    s_cmp_ge_u32 s41, 2457600
    s_cselect_b32 s41, s74, s41
    v_mov_b32 v180, 0x3f803f80
    v_mov_b32 v181, 0x3f803f80
    s_waitcnt lgkmcnt(4)
    v_mfma_f32_32x32x16_bf16 v[128:143], v[56:59], a[4:7], v[128:143]
    ds_read_b64_tr_b16 v[48:49], v39 offset:16384
    ds_read_b64_tr_b16 v[50:51], v39 offset:16896
    s_add_u32 m0, s48, 40960
    s_nop 0
    buffer_load_dwordx4 v17, s[8:11], s41 offen offset:0 lds
    s_add_u32 m0, s48, 40960
    s_nop 0
    buffer_load_dwordx4 v18, s[8:11], s41 offen offset:1024 lds
    v_mfma_f32_32x32x16_bf16 v[144:159], v[60:63], a[4:7], v[144:159]
    ds_read_b64_tr_b16 v[52:53], v43 offset:16384
    ds_read_b64_tr_b16 v[54:55], v43 offset:16896
    v_mov_b32 v182, 0x3f803f80
    v_mov_b32 v183, 0x3f803f80
    s_waitcnt lgkmcnt(4) vmcnt(17)
    s_barrier
    v_mfma_f32_32x32x16_bf16 v[128:143], v[64:67], a[8:11], v[128:143]
    ds_read_b64_tr_b16 v[56:57], v36 offset:24576
    ds_read_b64_tr_b16 v[58:59], v36 offset:25088
    ds_read_b64_tr_b16 v[160:161], v13 offset:16384
    ds_read_b64_tr_b16 v[162:163], v13 offset:16896
    v_mfma_f32_32x32x16_bf16 v[144:159], v[68:71], a[8:11], v[144:159]
    ds_read_b64_tr_b16 v[60:61], v40 offset:24576
    ds_read_b64_tr_b16 v[62:63], v40 offset:25088
    ds_read_b64_tr_b16 v[164:165], v13 offset:20480
    ds_read_b64_tr_b16 v[166:167], v13 offset:20992
    s_waitcnt lgkmcnt(8)
    v_mfma_f32_32x32x16_bf16 v[128:143], v[48:51], a[12:15], v[128:143]
    ds_read_b64_tr_b16 v[64:65], v37 offset:24576
    ds_read_b64_tr_b16 v[66:67], v37 offset:25088
    ds_read_b64_tr_b16 v[168:169], v13 offset:24576
    ds_read_b64_tr_b16 v[170:171], v13 offset:25088
    v_mfma_f32_32x32x16_bf16 v[144:159], v[52:55], a[12:15], v[144:159]
    ds_read_b64_tr_b16 v[68:69], v41 offset:24576
    ds_read_b64_tr_b16 v[70:71], v41 offset:25088
    s_waitcnt lgkmcnt(8)
    v_mfma_f32_32x32x16_bf16 v[128:143], v[56:59], a[16:19], v[128:143]
    ds_read_b64_tr_b16 v[48:49], v38 offset:24576
    ds_read_b64_tr_b16 v[50:51], v38 offset:25088
    v_mfma_f32_16x16x32_bf16 v[192:195], v[44:47], v[56:59], v[192:195]
    v_mfma_f32_16x16x32_bf16 v[196:199], v[44:47], v[60:63], v[196:199]
    v_mfma_f32_32x32x16_bf16 v[144:159], v[60:63], a[16:19], v[144:159]
    ds_read_b64_tr_b16 v[52:53], v42 offset:24576
    ds_read_b64_tr_b16 v[54:55], v42 offset:25088
    ds_read_b64_tr_b16 v[172:173], v13 offset:28672
    ds_read_b64_tr_b16 v[174:175], v13 offset:29184
    s_waitcnt lgkmcnt(6)
    v_mfma_f32_32x32x16_bf16 v[128:143], v[64:67], a[20:23], v[128:143]
    ds_read_b64_tr_b16 v[56:57], v39 offset:24576
    ds_read_b64_tr_b16 v[58:59], v39 offset:25088
    v_mfma_f32_16x16x32_bf16 v[176:179], v[180:183], v[160:163], 0
    v_mfma_f32_32x32x16_bf16 v[144:159], v[68:71], a[20:23], v[144:159]
    ds_read_b64_tr_b16 v[60:61], v43 offset:24576
    ds_read_b64_tr_b16 v[62:63], v43 offset:25088
    s_waitcnt lgkmcnt(6) vmcnt(4)
    s_barrier
    v_mfma_f32_32x32x16_bf16 v[128:143], v[48:51], a[24:27], v[128:143]
    ds_read_b64_tr_b16 v[64:65], v36 offset:32768
    ds_read_b64_tr_b16 v[66:67], v36 offset:33280
    s_cmp_lg_u32 s3, 0
    s_cbranch_scc1 Lw0_6
    v_mov_b32 v2, s54
    v_mov_b32 v3, s55
    v_mov_b32 v4, s54
    v_mov_b32 v5, s55
    s_mov_b64 exec, 0xff
    buffer_store_dwordx4 v[2:5], v16, s[12:15], s93 offen sc1
    s_mov_b64 exec, -1
Lw0_6:
    v_mfma_f32_16x16x32_bf16 v[176:179], v[180:183], v[164:167], v[176:179]
    v_mfma_f32_32x32x16_bf16 v[144:159], v[52:55], a[24:27], v[144:159]
    ds_read_b64_tr_b16 v[68:69], v40 offset:32768
    ds_read_b64_tr_b16 v[70:71], v40 offset:33280
    ds_read_b64_tr_b16 v[200:201], v33 offset:8192
    ds_read_b64_tr_b16 v[202:203], v33 offset:8704
    s_waitcnt lgkmcnt(6)
    v_mfma_f32_32x32x16_bf16 v[128:143], v[56:59], a[28:31], v[128:143]
    ds_read_b64_tr_b16 v[48:49], v37 offset:32768
    ds_read_b64_tr_b16 v[50:51], v37 offset:33280
    v_mfma_f32_16x16x32_bf16 v[176:179], v[180:183], v[168:171], v[176:179]
    v_mfma_f32_32x32x16_bf16 v[144:159], v[60:63], a[28:31], v[144:159]
    ds_read_b64_tr_b16 v[52:53], v41 offset:32768
    ds_read_b64_tr_b16 v[54:55], v41 offset:33280
    ds_read_b64_tr_b16 v[184:185], v33 offset:0
    ds_read_b64_tr_b16 v[186:187], v33 offset:512
    s_waitcnt lgkmcnt(8)
    v_mfma_f32_32x32x16_bf16 v[128:143], v[64:67], a[32:35], v[128:143]
    ds_read_b64_tr_b16 v[56:57], v38 offset:32768
    ds_read_b64_tr_b16 v[58:59], v38 offset:33280
    v_mfma_f32_16x16x32_bf16 v[192:195], v[44:47], v[64:67], v[192:195]
    v_mfma_f32_16x16x32_bf16 v[196:199], v[44:47], v[68:71], v[196:199]
    v_mfma_f32_16x16x32_bf16 v[176:179], v[180:183], v[172:175], v[176:179]
    v_mfma_f32_32x32x16_bf16 v[144:159], v[68:71], a[32:35], v[144:159]
    ds_read_b64_tr_b16 v[60:61], v42 offset:32768
    ds_read_b64_tr_b16 v[62:63], v42 offset:33280
    ds_read_b64_tr_b16 v[188:189], v33 offset:4096
    ds_read_b64_tr_b16 v[190:191], v33 offset:4608
    s_add_u32 m0, s90, 49280
    s_nop 0
    buffer_load_dwordx4 v10, s[32:35], s89 offen offset:0 lds
    s_waitcnt lgkmcnt(8)
    v_mfma_f32_32x32x16_bf16 v[128:143], v[48:51], a[36:39], v[128:143]
    ds_read_b64_tr_b16 v[64:65], v39 offset:32768
    ds_read_b64_tr_b16 v[66:67], v39 offset:33280
    v_lshlrev_b32 v34, 2, v1
    s_mov_b64 exec, 0xffff
    buffer_store_dword v176, v34, s[12:15], s75 offen sc1
    s_mov_b64 exec, -1
    buffer_store_dwordx4 v[200:203], v16, s[12:15], s57 offen sc1
    v_mfma_f32_32x32x16_bf16 v[144:159], v[52:55], a[36:39], v[144:159]
    ds_read_b64_tr_b16 v[68:69], v43 offset:32768
    ds_read_b64_tr_b16 v[70:71], v43 offset:33280
    buffer_load_dwordx4 v11, s[32:35], s89 offen offset:1024 lds
    s_waitcnt lgkmcnt(6)
    v_mfma_f32_32x32x16_bf16 v[128:143], v[56:59], a[40:43], v[128:143]
    ds_read_b64_tr_b16 v[48:49], v36 offset:40960
    ds_read_b64_tr_b16 v[50:51], v36 offset:41472
    buffer_store_dwordx4 v[184:187], v16, s[12:15], s71 offen sc1
    s_add_u32 s71, s71, 5120
    v_mfma_f32_32x32x16_bf16 v[144:159], v[60:63], a[40:43], v[144:159]
    ds_read_b64_tr_b16 v[52:53], v40 offset:40960
    ds_read_b64_tr_b16 v[54:55], v40 offset:41472
    buffer_load_dwordx4 v12, s[32:35], s89 offen offset:2048 lds
    s_add_u32 s89, s89, 98304
    s_waitcnt lgkmcnt(4)
    v_mfma_f32_32x32x16_bf16 v[128:143], v[64:67], a[44:47], v[128:143]
    ds_read_b64_tr_b16 v[56:57], v37 offset:40960
    ds_read_b64_tr_b16 v[58:59], v37 offset:41472
    buffer_store_dwordx4 v[188:191], v16, s[12:15], s71 offen sc1
    v_mfma_f32_32x32x16_bf16 v[144:159], v[68:71], a[44:47], v[144:159]
    ds_read_b64_tr_b16 v[60:61], v41 offset:40960
    ds_read_b64_tr_b16 v[62:63], v41 offset:41472
    s_add_u32 m0, s90, 61600
    s_nop 0
    buffer_load_dwordx4 v10, s[32:35], s89 offen offset:0 lds
    s_waitcnt lgkmcnt(4)
    v_mfma_f32_32x32x16_bf16 v[128:143], v[48:51], a[48:51], v[128:143]
    ds_read_b64_tr_b16 v[64:65], v38 offset:40960
    ds_read_b64_tr_b16 v[66:67], v38 offset:41472
    v_mfma_f32_16x16x32_bf16 v[192:195], v[44:47], v[48:51], v[192:195]
    v_mfma_f32_16x16x32_bf16 v[196:199], v[44:47], v[52:55], v[196:199]
    v_mfma_f32_32x32x16_bf16 v[144:159], v[52:55], a[48:51], v[144:159]
    ds_read_b64_tr_b16 v[68:69], v42 offset:40960
    ds_read_b64_tr_b16 v[70:71], v42 offset:41472
    buffer_load_dwordx4 v11, s[32:35], s89 offen offset:1024 lds
    v_accvgpr_read_b32 v34, a247
    buffer_load_dwordx4 v[20:23], v34, s[4:7], s78 offen
    s_waitcnt lgkmcnt(4)
    v_mfma_f32_32x32x16_bf16 v[128:143], v[56:59], a[52:55], v[128:143]
    ds_read_b64_tr_b16 v[48:49], v39 offset:40960
    ds_read_b64_tr_b16 v[50:51], v39 offset:41472
    buffer_load_dwordx4 v12, s[32:35], s89 offen offset:2048 lds
    s_add_u32 s89, s89, 98304
    v_mfma_f32_32x32x16_bf16 v[144:159], v[60:63], a[52:55], v[144:159]
    ds_read_b64_tr_b16 v[52:53], v43 offset:40960
    ds_read_b64_tr_b16 v[54:55], v43 offset:41472
    buffer_load_dwordx4 v[24:27], v34, s[4:7], s78 offen offset:64
    s_waitcnt lgkmcnt(4) vmcnt(12)
    s_barrier
    v_mfma_f32_32x32x16_bf16 v[128:143], v[64:67], a[56:59], v[128:143]
    v_add_u32 v36, 4294868992, v36
    ds_read_b64_tr_b16 v[56:57], v36 offset:32768
    ds_read_b64_tr_b16 v[58:59], v36 offset:33280
    s_add_u32 m0, s90, 0
    s_nop 0
    buffer_load_dwordx4 v10, s[32:35], s89 offen offset:0 lds
    v_mfma_f32_32x32x16_bf16 v[144:159], v[68:71], a[56:59], v[144:159]
    v_add_u32 v40, 4294868992, v40
    ds_read_b64_tr_b16 v[60:61], v40 offset:32768
    ds_read_b64_tr_b16 v[62:63], v40 offset:33280
    s_waitcnt lgkmcnt(4)
    v_mfma_f32_32x32x16_bf16 v[128:143], v[48:51], a[60:63], v[128:143]
    v_add_u32 v37, 4294868992, v37
    ds_read_b64_tr_b16 v[64:65], v37 offset:32768
    ds_read_b64_tr_b16 v[66:67], v37 offset:33280
    buffer_load_dwordx2 v[28:29], v35, s[4:7], s78 offen offset:128
    v_mfma_f32_32x32x16_bf16 v[144:159], v[52:55], a[60:63], v[144:159]
    v_add_u32 v41, 4294868992, v41
    ds_read_b64_tr_b16 v[68:69], v41 offset:32768
    ds_read_b64_tr_b16 v[70:71], v41 offset:33280
    s_waitcnt lgkmcnt(4)
    v_mfma_f32_32x32x16_bf16 v[128:143], v[56:59], a[64:67], v[128:143]
    v_add_u32 v38, 4294868992, v38
    ds_read_b64_tr_b16 v[48:49], v38 offset:32768
    ds_read_b64_tr_b16 v[50:51], v38 offset:33280
    v_mfma_f32_16x16x32_bf16 v[192:195], v[44:47], v[56:59], v[192:195]
    v_mfma_f32_32x32x16_bf16 v[144:159], v[60:63], a[64:67], v[144:159]
    v_add_u32 v42, 4294868992, v42
    ds_read_b64_tr_b16 v[52:53], v42 offset:32768
    ds_read_b64_tr_b16 v[54:55], v42 offset:33280
    v_mfma_f32_16x16x32_bf16 v[196:199], v[44:47], v[60:63], v[196:199]
    s_waitcnt lgkmcnt(4)
    v_mfma_f32_32x32x16_bf16 v[128:143], v[64:67], a[68:71], v[128:143]
    v_add_u32 v39, 4294868992, v39
    ds_read_b64_tr_b16 v[56:57], v39 offset:32768
    ds_read_b64_tr_b16 v[58:59], v39 offset:33280
    buffer_load_dwordx4 v11, s[32:35], s89 offen offset:1024 lds
    v_mfma_f32_32x32x16_bf16 v[144:159], v[68:71], a[68:71], v[144:159]
    v_add_u32 v43, 4294868992, v43
    ds_read_b64_tr_b16 v[60:61], v43 offset:32768
    ds_read_b64_tr_b16 v[62:63], v43 offset:33280
    s_waitcnt lgkmcnt(4) vmcnt(8)
    s_barrier
    s_cmp_lg_u32 s3, 0
    s_cbranch_scc1 Lw0_9
    v_mov_b32 v2, s54
    v_mov_b32 v3, s55
    v_mov_b32 v4, s54
    v_mov_b32 v5, s55
    s_mov_b64 exec, 0xff
    buffer_store_dwordx4 v[2:5], v16, s[12:15], s95 offen sc1
    s_mov_b64 exec, -1
Lw0_9:
    s_cmp_lg_u32 s3, 0
    s_cbranch_scc1 Lw0_10
    v_mov_b32 v2, s54
    v_mov_b32 v3, s55
    s_mov_b64 exec, 1
    buffer_store_dword v2, off, s[12:15], s60 sc1
    s_mov_b64 exec, -1
Lw0_10:
    v_mfma_f32_32x32x16_bf16 v[128:143], v[48:51], a[72:75], v[128:143]
    ds_read_b64_tr_b16 v[64:65], v36 offset:40960
    ds_read_b64_tr_b16 v[66:67], v36 offset:41472
    v_mfma_f32_32x32x16_bf16 v[144:159], v[52:55], a[72:75], v[144:159]
    ds_read_b64_tr_b16 v[68:69], v40 offset:40960
    ds_read_b64_tr_b16 v[70:71], v40 offset:41472
    s_waitcnt lgkmcnt(4)
    v_mfma_f32_32x32x16_bf16 v[128:143], v[56:59], a[76:79], v[128:143]
    ds_read_b64_tr_b16 v[48:49], v37 offset:40960
    ds_read_b64_tr_b16 v[50:51], v37 offset:41472
    v_mfma_f32_32x32x16_bf16 v[144:159], v[60:63], a[76:79], v[144:159]
    ds_read_b64_tr_b16 v[52:53], v41 offset:40960
    ds_read_b64_tr_b16 v[54:55], v41 offset:41472
    s_waitcnt lgkmcnt(4)
    v_mfma_f32_32x32x16_bf16 v[128:143], v[64:67], a[80:83], v[128:143]
    ds_read_b64_tr_b16 v[56:57], v38 offset:40960
    ds_read_b64_tr_b16 v[58:59], v38 offset:41472
    v_mfma_f32_16x16x32_bf16 v[192:195], v[44:47], v[64:67], v[192:195]
    v_mfma_f32_16x16x32_bf16 v[196:199], v[44:47], v[68:71], v[196:199]
    v_mfma_f32_32x32x16_bf16 v[144:159], v[68:71], a[80:83], v[144:159]
    ds_read_b64_tr_b16 v[60:61], v42 offset:40960
    ds_read_b64_tr_b16 v[62:63], v42 offset:41472
    buffer_load_dwordx4 v12, s[32:35], s89 offen offset:2048 lds
    s_add_u32 s89, s89, 98304
    s_waitcnt lgkmcnt(4)
    v_mfma_f32_32x32x16_bf16 v[128:143], v[48:51], a[84:87], v[128:143]
    ds_read_b64_tr_b16 v[64:65], v39 offset:40960
    ds_read_b64_tr_b16 v[66:67], v39 offset:41472
    v_mfma_f32_32x32x16_bf16 v[144:159], v[52:55], a[84:87], v[144:159]
    ds_read_b64_tr_b16 v[68:69], v43 offset:40960
    ds_read_b64_tr_b16 v[70:71], v43 offset:41472
    s_waitcnt lgkmcnt(4)
    v_mfma_f32_32x32x16_bf16 v[128:143], v[56:59], a[88:91], v[128:143]
    v_add_u32 v36, 65536, v36
    ds_read_b64_tr_b16 v[48:49], v36 offset:16384
    ds_read_b64_tr_b16 v[50:51], v36 offset:16896
    v_accvgpr_read_b32 v121, a171
    v_mfma_f32_32x32x16_bf16 v[144:159], v[60:63], a[88:91], v[144:159]
    v_add_u32 v40, 65536, v40
    ds_read_b64_tr_b16 v[52:53], v40 offset:16384
    ds_read_b64_tr_b16 v[54:55], v40 offset:16896
    s_waitcnt lgkmcnt(4)
    v_mfma_f32_32x32x16_bf16 v[128:143], v[64:67], a[92:95], v[128:143]
    v_add_u32 v37, 65536, v37
    ds_read_b64_tr_b16 v[56:57], v37 offset:16384
    ds_read_b64_tr_b16 v[58:59], v37 offset:16896
    s_add_u32 m0, s90, 12320
    s_nop 0
    buffer_load_dwordx4 v10, s[32:35], s89 offen offset:0 lds
    v_mfma_f32_32x32x16_bf16 v[144:159], v[68:71], a[92:95], v[144:159]
    v_add_u32 v41, 65536, v41
    ds_read_b64_tr_b16 v[60:61], v41 offset:16384
    ds_read_b64_tr_b16 v[62:63], v41 offset:16896
    ds_read_b64_tr_b16 v[84:85], v121 offset:0
    s_waitcnt lgkmcnt(5)
    v_mfma_f32_32x32x16_bf16 v[128:143], v[48:51], a[96:99], v[128:143]
    v_add_u32 v38, 65536, v38
    ds_read_b64_tr_b16 v[64:65], v38 offset:16384
    ds_read_b64_tr_b16 v[66:67], v38 offset:16896
    v_mfma_f32_16x16x32_bf16 v[192:195], v[44:47], v[48:51], v[192:195]
    v_mfma_f32_16x16x32_bf16 v[196:199], v[44:47], v[52:55], v[196:199]
    v_mfma_f32_32x32x16_bf16 v[144:159], v[52:55], a[96:99], v[144:159]
    v_add_u32 v42, 65536, v42
    ds_read_b64_tr_b16 v[68:69], v42 offset:16384
    ds_read_b64_tr_b16 v[70:71], v42 offset:16896
    ds_read_b64_tr_b16 v[86:87], v121 offset:160
    s_waitcnt lgkmcnt(6)
    v_mfma_f32_32x32x16_bf16 v[128:143], v[56:59], a[100:103], v[128:143]
    v_add_u32 v39, 65536, v39
    ds_read_b64_tr_b16 v[48:49], v39 offset:16384
    ds_read_b64_tr_b16 v[50:51], v39 offset:16896
    ds_read_b64_tr_b16 v[88:89], v121 offset:32
    v_mfma_f32_32x32x16_bf16 v[144:159], v[60:63], a[100:103], v[144:159]
    v_add_u32 v43, 65536, v43
    ds_read_b64_tr_b16 v[52:53], v43 offset:16384
    ds_read_b64_tr_b16 v[54:55], v43 offset:16896
    s_waitcnt lgkmcnt(6)
    v_mfma_f32_32x32x16_bf16 v[128:143], v[64:67], a[104:107], v[128:143]
    ds_read_b64_tr_b16 v[56:57], v36 offset:24576
    ds_read_b64_tr_b16 v[58:59], v36 offset:25088
    buffer_load_dwordx4 v11, s[32:35], s89 offen offset:1024 lds
    v_mfma_f32_32x32x16_bf16 v[144:159], v[68:71], a[104:107], v[144:159]
    ds_read_b64_tr_b16 v[60:61], v40 offset:24576
    ds_read_b64_tr_b16 v[62:63], v40 offset:25088
    ds_read_b64_tr_b16 v[90:91], v121 offset:192
    s_waitcnt lgkmcnt(5)
    v_mfma_f32_32x32x16_bf16 v[128:143], v[48:51], a[108:111], v[128:143]
    ds_read_b64_tr_b16 v[64:65], v37 offset:24576
    ds_read_b64_tr_b16 v[66:67], v37 offset:25088
    ds_read_b64_tr_b16 v[92:93], v121 offset:320
    v_mfma_f32_32x32x16_bf16 v[144:159], v[52:55], a[108:111], v[144:159]
    ds_read_b64_tr_b16 v[68:69], v41 offset:24576
    ds_read_b64_tr_b16 v[70:71], v41 offset:25088
    s_waitcnt lgkmcnt(6)
    v_mfma_f32_32x32x16_bf16 v[128:143], v[56:59], a[112:115], v[128:143]
    ds_read_b64_tr_b16 v[48:49], v38 offset:24576
    ds_read_b64_tr_b16 v[50:51], v38 offset:25088
    v_mfma_f32_16x16x32_bf16 v[192:195], v[44:47], v[56:59], v[192:195]
    v_mfma_f32_16x16x32_bf16 v[196:199], v[44:47], v[60:63], v[196:199]
    v_mfma_f32_32x32x16_bf16 v[144:159], v[60:63], a[112:115], v[144:159]
    ds_read_b64_tr_b16 v[52:53], v42 offset:24576
    ds_read_b64_tr_b16 v[54:55], v42 offset:25088
    ds_read_b64_tr_b16 v[94:95], v121 offset:480
    s_waitcnt lgkmcnt(5)
    v_mfma_f32_32x32x16_bf16 v[128:143], v[64:67], a[116:119], v[128:143]
    ds_read_b64_tr_b16 v[56:57], v39 offset:24576
    ds_read_b64_tr_b16 v[58:59], v39 offset:25088
    buffer_load_dwordx4 v12, s[32:35], s89 offen offset:2048 lds
    s_add_u32 s89, s89, 98304
    v_mfma_f32_32x32x16_bf16 v[144:159], v[68:71], a[116:119], v[144:159]
    ds_read_b64_tr_b16 v[60:61], v43 offset:24576
    ds_read_b64_tr_b16 v[62:63], v43 offset:25088
    ds_read_b64_tr_b16 v[96:97], v121 offset:352
    s_waitcnt lgkmcnt(6)
    v_mfma_f32_32x32x16_bf16 v[128:143], v[48:51], a[120:123], v[128:143]
    ds_read_b64_tr_b16 v[64:65], v36 offset:32768
    ds_read_b64_tr_b16 v[66:67], v36 offset:33280
    s_cmp_lg_u32 s3, 0
    s_cbranch_scc1 Lw0_8
    v_mov_b32_e64 v9, 0
    buffer_load_dword v9, off, s[12:15], s97 offset:0
    buffer_load_dword v9, off, s[12:15], s97 offset:2048
    s_add_u32 s51, s97, 4096
    buffer_load_dword v9, off, s[12:15], s51
Lw0_8:
    v_mfma_f32_32x32x16_bf16 v[144:159], v[52:55], a[120:123], v[144:159]
    ds_read_b64_tr_b16 v[68:69], v40 offset:32768
    ds_read_b64_tr_b16 v[70:71], v40 offset:33280
    ds_read_b64_tr_b16 v[98:99], v121 offset:512
    s_waitcnt lgkmcnt(6)
    v_mfma_f32_32x32x16_bf16 v[128:143], v[56:59], a[124:127], v[128:143]
    ds_read_b64_tr_b16 v[48:49], v37 offset:32768
    ds_read_b64_tr_b16 v[50:51], v37 offset:33280
    ds_read_b64_tr_b16 v[100:101], v121 offset:640
    v_mfma_f32_32x32x16_bf16 v[144:159], v[60:63], a[124:127], v[144:159]
    ds_read_b64_tr_b16 v[52:53], v41 offset:32768
    ds_read_b64_tr_b16 v[54:55], v41 offset:33280
    s_waitcnt lgkmcnt(6)
    v_mfma_f32_32x32x16_bf16 v[128:143], v[64:67], a[128:131], v[128:143]
    ds_read_b64_tr_b16 v[56:57], v38 offset:32768
    ds_read_b64_tr_b16 v[58:59], v38 offset:33280
    v_mfma_f32_16x16x32_bf16 v[192:195], v[44:47], v[64:67], v[192:195]
    v_mfma_f32_16x16x32_bf16 v[196:199], v[44:47], v[68:71], v[196:199]
    v_mfma_f32_32x32x16_bf16 v[144:159], v[68:71], a[128:131], v[144:159]
    ds_read_b64_tr_b16 v[60:61], v42 offset:32768
    ds_read_b64_tr_b16 v[62:63], v42 offset:33280
    ds_read_b64_tr_b16 v[102:103], v121 offset:800
    s_waitcnt lgkmcnt(5)
    v_mfma_f32_32x32x16_bf16 v[128:143], v[48:51], a[132:135], v[128:143]
    ds_read_b64_tr_b16 v[64:65], v39 offset:32768
    ds_read_b64_tr_b16 v[66:67], v39 offset:33280
    s_lshl_b32 s51, s36, 11
    s_add_u32 s51, s51, 22085632
    s_cmp_lg_u32 s3, 0
    s_cbranch_scc1 Lw0_7
    buffer_load_dword v34, v7, s[12:15], s51 offen sc1
    buffer_load_dwordx2 v[30:31], v7, s[12:15], s94 offen sc1
Lw0_7:
    v_mfma_f32_32x32x16_bf16 v[144:159], v[52:55], a[132:135], v[144:159]
    ds_read_b64_tr_b16 v[68:69], v43 offset:32768
    ds_read_b64_tr_b16 v[70:71], v43 offset:33280
    ds_read_b64_tr_b16 v[104:105], v121 offset:672
    s_waitcnt lgkmcnt(6)
    v_mfma_f32_32x32x16_bf16 v[128:143], v[56:59], a[136:139], v[128:143]
    ds_read_b64_tr_b16 v[48:49], v36 offset:40960
    ds_read_b64_tr_b16 v[50:51], v36 offset:41472
    ds_read_b64_tr_b16 v[106:107], v121 offset:832
    v_mfma_f32_32x32x16_bf16 v[144:159], v[60:63], a[136:139], v[144:159]
    ds_read_b64_tr_b16 v[52:53], v40 offset:40960
    ds_read_b64_tr_b16 v[54:55], v40 offset:41472
    s_waitcnt lgkmcnt(6)
    v_mfma_f32_32x32x16_bf16 v[128:143], v[64:67], a[140:143], v[128:143]
    ds_read_b64_tr_b16 v[56:57], v37 offset:40960
    ds_read_b64_tr_b16 v[58:59], v37 offset:41472
    v_mfma_f32_32x32x16_bf16 v[144:159], v[68:71], a[140:143], v[144:159]
    ds_read_b64_tr_b16 v[60:61], v41 offset:40960
    ds_read_b64_tr_b16 v[62:63], v41 offset:41472
    s_waitcnt lgkmcnt(4)
    v_mfma_f32_32x32x16_bf16 v[128:143], v[48:51], a[144:147], v[128:143]
    ds_read_b64_tr_b16 v[64:65], v38 offset:40960
    ds_read_b64_tr_b16 v[66:67], v38 offset:41472
    v_mfma_f32_16x16x32_bf16 v[192:195], v[44:47], v[48:51], v[192:195]
    v_mfma_f32_16x16x32_bf16 v[196:199], v[44:47], v[52:55], v[196:199]
    v_mfma_f32_32x32x16_bf16 v[144:159], v[52:55], a[144:147], v[144:159]
    ds_read_b64_tr_b16 v[68:69], v42 offset:40960
    ds_read_b64_tr_b16 v[70:71], v42 offset:41472
    v_accvgpr_read_b32 v18, a166
    s_waitcnt lgkmcnt(4)
    v_mfma_f32_32x32x16_bf16 v[128:143], v[56:59], a[148:151], v[128:143]
    ds_read_b64_tr_b16 v[48:49], v39 offset:40960
    ds_read_b64_tr_b16 v[50:51], v39 offset:41472
    v_lshlrev_b32 v208, 2, v1
    s_mul_i32 s53, s3, 384
    s_add_u32 s53, s53, 4096
    v_add_u32 v208, s53, v208
    s_mov_b64 exec, 0xffff
    ds_write2_b32 v208, v192, v193 offset0:0 offset1:16
    ds_write2_b32 v208, v196, v197 offset0:32 offset1:48
    s_mov_b64 exec, -1
    v_mfma_f32_32x32x16_bf16 v[144:159], v[60:63], a[148:151], v[144:159]
    ds_read_b64_tr_b16 v[52:53], v43 offset:40960
    ds_read_b64_tr_b16 v[54:55], v43 offset:41472
    s_waitcnt lgkmcnt(2)
    s_barrier
    v_mfma_f32_32x32x16_bf16 v[128:143], v[64:67], a[152:155], v[128:143]
    v_min_u32 v208, 64, v0
    v_lshlrev_b32_e64 v208, 2, v208
    v_mfma_f32_32x32x16_bf16 v[144:159], v[68:71], a[152:155], v[144:159]
    ds_read_b32 v210, v208 offset:4096
    ds_read_b32 v211, v208 offset:4480
    ds_read_b32 v212, v208 offset:4864
    ds_read_b32 v213, v208 offset:5248
    s_waitcnt lgkmcnt(4)
    v_mfma_f32_32x32x16_bf16 v[128:143], v[48:51], a[156:159], v[128:143]
    s_waitcnt lgkmcnt(0)
    v_add_f32 v210, v210, v211
    v_add_f32 v212, v212, v213
    v_add_f32 v210, v210, v212
    ds_write_b32 v208, v210 offset:384
    v_mfma_f32_32x32x16_bf16 v[144:159], v[52:55], a[156:159], v[144:159]
    s_cmp_lg_u32 s3, 0
    s_cbranch_scc1 Lw0_17
    s_waitcnt vmcnt(0)
    v_cmp_ne_u64 vcc, s[54:55], v[30:31]
    s_cbranch_vccnz Ls_11
Lb_12:
    s_and_b32 s49, s54, -16
    v_and_b32 v2, -16, v34
    v_cmp_ne_u32 vcc, s49, v2
    s_cbranch_vccnz Ls_14
Lb_15:
    v_and_b32 v2, 15, v34
    v_cmp_ne_u32 vcc, s99, v2
    s_nop 0
    s_cmp_eq_u64 vcc, 0
    s_cselect_b32 s98, 1, 0
Lw0_17:
    s_waitcnt lgkmcnt(0)
    s_barrier
    ds_read_b128 v[204:207], v19 offset:384
    ds_read_b128 v[208:211], v19 offset:416
    ds_read_b128 v[212:215], v19 offset:448
    ds_read_b128 v[216:219], v19 offset:480
    ds_read_b128 v[220:223], v19 offset:512
    buffer_load_dwordx4 v[40:43], v80, s[12:15], s91 offen sc1
    s_add_u32 s91, s91, 4096
    buffer_load_dwordx4 v[44:47], v80, s[12:15], s91 offen sc1
    s_add_u32 s91, s91, 4096
    buffer_load_dwordx4 v[48:51], v80, s[12:15], s91 offen sc1
    s_add_u32 s91, s91, 4096
    s_mul_i32 s63, s39, 102400
    s_mul_i32 s49, s3, 25600
    s_add_u32 s63, s63, s49
    s_add_u32 s63, s63, 20971520
    v_mov_b32 v254, 0
    buffer_load_dwordx4 v[52:55], v80, s[12:15], s91 offen sc1
    s_add_u32 s91, s91, 4096
    v_mov_b32 v255, 0
    s_waitcnt lgkmcnt(4)
    v_pk_fma_f32 v[128:129], v[204:205], v[74:75], v[128:129] op_sel:[0,1,0] op_sel_hi:[1,1,1]
    v_pk_fma_f32 v[130:131], v[206:207], v[74:75], v[130:131] op_sel:[0,1,0] op_sel_hi:[1,1,1]
    v_cvt_pk_bf16_f32 v244, v128, v129
    v_cvt_pk_bf16_f32 v245, v130, v131
    s_waitcnt lgkmcnt(3)
    v_pk_fma_f32 v[132:133], v[208:209], v[74:75], v[132:133] op_sel:[0,1,0] op_sel_hi:[1,1,1]
    v_pk_fma_f32 v[134:135], v[210:211], v[74:75], v[134:135] op_sel:[0,1,0] op_sel_hi:[1,1,1]
    v_cvt_pk_bf16_f32 v246, v132, v133
    v_cvt_pk_bf16_f32 v247, v134, v135
    s_waitcnt lgkmcnt(2)
    v_pk_fma_f32 v[136:137], v[212:213], v[74:75], v[136:137] op_sel:[0,1,0] op_sel_hi:[1,1,1]
    buffer_load_dwordx4 v[56:59], v80, s[12:15], s91 offen sc1
    s_add_u32 s91, s91, 4096
    v_pk_fma_f32 v[138:139], v[214:215], v[74:75], v[138:139] op_sel:[0,1,0] op_sel_hi:[1,1,1]
    v_cvt_pk_bf16_f32 v248, v136, v137
    v_cvt_pk_bf16_f32 v249, v138, v139
    s_waitcnt lgkmcnt(1)
    v_pk_fma_f32 v[140:141], v[216:217], v[74:75], v[140:141] op_sel:[0,1,0] op_sel_hi:[1,1,1]
    v_pk_fma_f32 v[142:143], v[218:219], v[74:75], v[142:143] op_sel:[0,1,0] op_sel_hi:[1,1,1]
    v_cvt_pk_bf16_f32 v250, v140, v141
    v_cvt_pk_bf16_f32 v251, v142, v143
    s_waitcnt lgkmcnt(0)
    v_pk_fma_f32 v[144:145], v[220:221], v[74:75], v[144:145] op_sel:[0,1,0] op_sel_hi:[1,1,1]
    v_pk_fma_f32 v[146:147], v[222:223], v[74:75], v[146:147] op_sel:[0,1,0] op_sel_hi:[1,1,1]
    v_cvt_pk_bf16_f32 v252, v144, v145
    v_cvt_pk_bf16_f32 v253, v146, v147
    buffer_load_dwordx4 v[60:63], v80, s[12:15], s91 offen sc1
    s_add_u32 s91, s91, 4096
    v_mfma_f32_32x32x16_bf16 v[204:219], v[84:87], v[244:247], 0
    v_mfma_f32_32x32x16_bf16 v[220:235], v[88:91], v[244:247], 0
    v_mfma_f32_32x32x16_bf16 v[204:219], v[92:95], v[248:251], v[204:219]
    buffer_load_dwordx4 v[64:67], v80, s[12:15], s91 offen sc1
    s_add_u32 s91, s91, 4096
    v_mfma_f32_32x32x16_bf16 v[220:235], v[96:99], v[248:251], v[220:235]
    buffer_load_dwordx4 v[68:71], v80, s[12:15], s91 offen sc1
    s_add_u32 s91, s91, 4096
    v_mfma_f32_32x32x16_bf16 v[204:219], v[100:103], v[252:255], v[204:219]
    v_mfma_f32_32x32x16_bf16 v[220:235], v[104:107], v[252:255], v[220:235]
    buffer_load_dwordx4 v[168:171], v80, s[12:15], s91 offen sc1
    s_add_u32 s91, s91, 4096
    v_mul_f32 v8, 0x3fb8aa3b, v76
    s_nop 7
    v_max3_f32 v2, v204, v205, v206
    v_min3_f32 v3, v204, v205, v206
    v_max3_f32 v4, v207, v208, v209
    buffer_load_dwordx4 v[172:175], v80, s[12:15], s91 offen sc1
    s_add_u32 s91, s91, 4096
    v_min3_f32 v5, v207, v208, v209
    v_max3_f32 v2, v210, v211, v2
    v_min3_f32 v3, v210, v211, v3
    v_max3_f32 v4, v212, v213, v4
    v_min3_f32 v5, v212, v213, v5
    v_max3_f32 v2, v214, v215, v2
    v_min3_f32 v3, v214, v215, v3
    v_max3_f32 v4, v216, v217, v4
    v_min3_f32 v5, v216, v217, v5
    v_max3_f32 v2, v218, v219, v2
    v_min3_f32 v3, v218, v219, v3
    buffer_load_dwordx4 v[176:179], v80, s[12:15], s91 offen sc1
    s_add_u32 s91, s91, 4096
    v_max3_f32 v4, v220, v221, v4
    v_min3_f32 v5, v220, v221, v5
    v_max3_f32 v2, v222, v223, v2
    v_min3_f32 v3, v222, v223, v3
    v_max_f32 v2, v2, v4
    v_min_f32_e64 v3, v3, v5
    v_pk_mul_f32 v[6:7], v[2:3], v[8:9] op_sel_hi:[1,0]
    v_pk_fma_f32 v[128:129], v[204:205], v[8:9], v[6:7] op_sel_hi:[1,0,0] neg_lo:[0,0,1] neg_hi:[0,0,1]
    v_pk_fma_f32 v[148:149], v[204:205], v[8:9], v[6:7] op_sel:[0,0,1] op_sel_hi:[1,0,1] neg_lo:[1,0,0] neg_hi:[1,0,0]
    v_pk_fma_f32 v[130:131], v[206:207], v[8:9], v[6:7] op_sel_hi:[1,0,0] neg_lo:[0,0,1] neg_hi:[0,0,1]
    v_pk_fma_f32 v[150:151], v[206:207], v[8:9], v[6:7] op_sel:[0,0,1] op_sel_hi:[1,0,1] neg_lo:[1,0,0] neg_hi:[1,0,0]
    buffer_load_dwordx4 v[180:183], v80, s[12:15], s91 offen sc1
    s_add_u32 s91, s91, 4096
    v_pk_fma_f32 v[132:133], v[208:209], v[8:9], v[6:7] op_sel_hi:[1,0,0] neg_lo:[0,0,1] neg_hi:[0,0,1]
    v_pk_fma_f32 v[152:153], v[208:209], v[8:9], v[6:7] op_sel:[0,0,1] op_sel_hi:[1,0,1] neg_lo:[1,0,0] neg_hi:[1,0,0]
    v_pk_fma_f32 v[134:135], v[210:211], v[8:9], v[6:7] op_sel_hi:[1,0,0] neg_lo:[0,0,1] neg_hi:[0,0,1]
    v_pk_fma_f32 v[154:155], v[210:211], v[8:9], v[6:7] op_sel:[0,0,1] op_sel_hi:[1,0,1] neg_lo:[1,0,0] neg_hi:[1,0,0]
    v_pk_fma_f32 v[136:137], v[212:213], v[8:9], v[6:7] op_sel_hi:[1,0,0] neg_lo:[0,0,1] neg_hi:[0,0,1]
    v_pk_fma_f32 v[156:157], v[212:213], v[8:9], v[6:7] op_sel:[0,0,1] op_sel_hi:[1,0,1] neg_lo:[1,0,0] neg_hi:[1,0,0]
    v_pk_fma_f32 v[138:139], v[214:215], v[8:9], v[6:7] op_sel_hi:[1,0,0] neg_lo:[0,0,1] neg_hi:[0,0,1]
    v_pk_fma_f32 v[158:159], v[214:215], v[8:9], v[6:7] op_sel:[0,0,1] op_sel_hi:[1,0,1] neg_lo:[1,0,0] neg_hi:[1,0,0]
    v_pk_fma_f32 v[140:141], v[216:217], v[8:9], v[6:7] op_sel_hi:[1,0,0] neg_lo:[0,0,1] neg_hi:[0,0,1]
    v_pk_fma_f32 v[160:161], v[216:217], v[8:9], v[6:7] op_sel:[0,0,1] op_sel_hi:[1,0,1] neg_lo:[1,0,0] neg_hi:[1,0,0]
    v_pk_fma_f32 v[142:143], v[218:219], v[8:9], v[6:7] op_sel_hi:[1,0,0] neg_lo:[0,0,1] neg_hi:[0,0,1]
    buffer_load_dwordx4 v[184:187], v80, s[12:15], s91 offen sc1
    s_add_u32 s91, s91, 4096
    v_pk_fma_f32 v[162:163], v[218:219], v[8:9], v[6:7] op_sel:[0,0,1] op_sel_hi:[1,0,1] neg_lo:[1,0,0] neg_hi:[1,0,0]
    v_pk_fma_f32 v[144:145], v[220:221], v[8:9], v[6:7] op_sel_hi:[1,0,0] neg_lo:[0,0,1] neg_hi:[0,0,1]
    v_pk_fma_f32 v[164:165], v[220:221], v[8:9], v[6:7] op_sel:[0,0,1] op_sel_hi:[1,0,1] neg_lo:[1,0,0] neg_hi:[1,0,0]
    v_pk_fma_f32 v[146:147], v[222:223], v[8:9], v[6:7] op_sel_hi:[1,0,0] neg_lo:[0,0,1] neg_hi:[0,0,1]
    v_pk_fma_f32 v[166:167], v[222:223], v[8:9], v[6:7] op_sel:[0,0,1] op_sel_hi:[1,0,1] neg_lo:[1,0,0] neg_hi:[1,0,0]
    v_exp_f32 v128, v128
    v_exp_f32 v148, v148
    v_exp_f32 v129, v129
    buffer_load_dwordx4 v[188:191], v80, s[12:15], s91 offen sc1
    s_add_u32 s91, s91, 4096
    v_exp_f32 v149, v149
    v_exp_f32 v130, v130
    v_exp_f32 v150, v150
    v_exp_f32 v131, v131
    v_exp_f32 v151, v151
    buffer_load_dwordx4 v[192:195], v80, s[12:15], s91 offen sc1
    s_add_u32 s91, s91, 4096
    v_exp_f32 v132, v132
    v_exp_f32 v152, v152
    v_exp_f32 v133, v133
    v_exp_f32 v153, v153
    v_exp_f32 v134, v134
    v_exp_f32 v154, v154
    buffer_load_dwordx4 v[196:199], v80, s[12:15], s91 offen sc1
    v_exp_f32 v135, v135
    v_exp_f32 v155, v155
    v_exp_f32 v136, v136
    v_exp_f32 v156, v156
    v_exp_f32 v137, v137
    s_cmp_lg_u32 s3, 0
    s_cbranch_scc1 Lw0_22
    v_accvgpr_read_b32 v238, a250
    s_mov_b32 s52, 22052864
    buffer_load_dwordx2 v[236:237], v238, s[12:15], s52 offen sc1
Lw0_22:
    v_exp_f32 v157, v157
    v_exp_f32 v138, v138
    v_exp_f32 v158, v158
    v_exp_f32 v139, v139
    v_exp_f32 v159, v159
    v_exp_f32 v140, v140
    v_exp_f32 v160, v160
    v_exp_f32 v141, v141
    v_exp_f32 v161, v161
    v_exp_f32 v142, v142
    v_exp_f32 v162, v162
    v_exp_f32 v143, v143
    v_exp_f32 v163, v163
    v_exp_f32 v144, v144
    v_exp_f32 v164, v164
    v_exp_f32 v145, v145
    v_exp_f32 v165, v165
    v_exp_f32 v146, v146
    v_exp_f32 v166, v166
    v_exp_f32 v147, v147
    v_exp_f32_e64 v167, v167
    v_pk_add_f32 v[2:3], v[128:129], v[130:131]
    v_pk_add_f32 v[4:5], v[148:149], v[150:151]
    v_pk_add_f32 v[2:3], v[2:3], v[132:133]
    v_pk_add_f32 v[4:5], v[4:5], v[152:153]
    v_pk_add_f32 v[2:3], v[2:3], v[134:135]
    v_pk_add_f32 v[4:5], v[4:5], v[154:155]
    v_pk_add_f32 v[2:3], v[2:3], v[136:137]
    v_pk_add_f32 v[4:5], v[4:5], v[156:157]
    v_pk_add_f32 v[2:3], v[2:3], v[138:139]
    v_pk_add_f32 v[4:5], v[4:5], v[158:159]
    v_pk_add_f32 v[2:3], v[2:3], v[140:141]
    v_pk_add_f32 v[4:5], v[4:5], v[160:161]
    v_pk_add_f32 v[2:3], v[2:3], v[142:143]
    v_pk_add_f32 v[4:5], v[4:5], v[162:163]
    v_pk_add_f32 v[2:3], v[2:3], v[144:145]
    v_pk_add_f32 v[4:5], v[4:5], v[164:165]
    v_pk_add_f32 v[2:3], v[2:3], v[146:147]
    v_pk_add_f32 v[4:5], v[4:5], v[166:167]
    v_add_f32 v2, v2, v3
    v_add_f32 v4, v4, v5
    v_rcp_f32 v2, v2
    v_rcp_f32 v4, v4
    v_pk_mul_f32 v[128:129], v[128:129], v[2:3] op_sel_hi:[1,0]
    v_pk_mul_f32 v[130:131], v[130:131], v[2:3] op_sel_hi:[1,0]
    v_cvt_pk_bf16_f32 v104, v128, v129
    v_cvt_pk_bf16_f32 v105, v130, v131
    v_pk_mul_f32 v[132:133], v[132:133], v[2:3] op_sel_hi:[1,0]
    v_pk_mul_f32 v[134:135], v[134:135], v[2:3] op_sel_hi:[1,0]
    v_cvt_pk_bf16_f32 v106, v132, v133
    v_cvt_pk_bf16_f32 v107, v134, v135
    v_pk_mul_f32 v[136:137], v[136:137], v[2:3] op_sel_hi:[1,0]
    v_pk_mul_f32 v[138:139], v[138:139], v[2:3] op_sel_hi:[1,0]
    v_cvt_pk_bf16_f32 v108, v136, v137
    v_cvt_pk_bf16_f32 v109, v138, v139
    v_pk_mul_f32 v[140:141], v[140:141], v[2:3] op_sel_hi:[1,0]
    v_pk_mul_f32 v[142:143], v[142:143], v[2:3] op_sel_hi:[1,0]
    v_cvt_pk_bf16_f32 v110, v140, v141
    v_cvt_pk_bf16_f32 v111, v142, v143
    v_pk_mul_f32 v[144:145], v[144:145], v[2:3] op_sel_hi:[1,0]
    v_pk_mul_f32 v[146:147], v[146:147], v[2:3] op_sel_hi:[1,0]
    v_cvt_pk_bf16_f32 v112, v144, v145
    v_cvt_pk_bf16_f32 v113, v146, v147
    v_pk_mul_f32 v[148:149], v[148:149], v[4:5] op_sel_hi:[1,0]
    v_pk_mul_f32 v[150:151], v[150:151], v[4:5] op_sel_hi:[1,0]
    v_cvt_pk_bf16_f32 v114, v148, v149
    v_cvt_pk_bf16_f32 v115, v150, v151
    v_pk_mul_f32 v[152:153], v[152:153], v[4:5] op_sel_hi:[1,0]
    v_pk_mul_f32 v[154:155], v[154:155], v[4:5] op_sel_hi:[1,0]
    v_cvt_pk_bf16_f32 v116, v152, v153
    v_cvt_pk_bf16_f32 v117, v154, v155
    v_pk_mul_f32 v[156:157], v[156:157], v[4:5] op_sel_hi:[1,0]
    v_pk_mul_f32 v[158:159], v[158:159], v[4:5] op_sel_hi:[1,0]
    v_cvt_pk_bf16_f32 v118, v156, v157
    v_cvt_pk_bf16_f32 v119, v158, v159
    v_pk_mul_f32 v[160:161], v[160:161], v[4:5] op_sel_hi:[1,0]
    v_pk_mul_f32 v[162:163], v[162:163], v[4:5] op_sel_hi:[1,0]
    v_cvt_pk_bf16_f32 v120, v160, v161
    v_cvt_pk_bf16_f32 v121, v162, v163
    v_pk_mul_f32 v[164:165], v[164:165], v[4:5] op_sel_hi:[1,0]
    v_pk_mul_f32 v[166:167], v[166:167], v[4:5] op_sel_hi:[1,0]
    v_cvt_pk_bf16_f32 v122, v164, v165
    v_cvt_pk_bf16_f32 v123, v166, v167
    v_mov_b32 v6, 0x3f80
    v_mov_b32 v7, 0x3f800000
    s_waitcnt vmcnt(15)
    v_lshlrev_b32 v204, 16, v40
    v_and_b32 v205, 0xffff0000, v40
    v_lshlrev_b32 v206, 16, v41
    v_and_b32 v207, 0xffff0000, v41
    v_lshlrev_b32 v208, 16, v42
    v_and_b32 v209, 0xffff0000, v42
    v_lshlrev_b32 v210, 16, v43
    v_and_b32 v211, 0xffff0000, v43
    s_waitcnt vmcnt(14)
    v_dot2c_f32_bf16 v204, v44, v6
    v_dot2c_f32_bf16 v205, v44, v7
    v_dot2c_f32_bf16 v206, v45, v6
    v_dot2c_f32_bf16 v207, v45, v7
    v_dot2c_f32_bf16 v208, v46, v6
    v_dot2c_f32_bf16 v209, v46, v7
    v_dot2c_f32_bf16 v210, v47, v6
    v_dot2c_f32_bf16 v211, v47, v7
    s_waitcnt vmcnt(13)
    v_dot2c_f32_bf16 v204, v48, v6
    v_dot2c_f32_bf16 v205, v48, v7
    v_dot2c_f32_bf16 v206, v49, v6
    v_dot2c_f32_bf16 v207, v49, v7
    v_dot2c_f32_bf16 v208, v50, v6
    v_dot2c_f32_bf16 v209, v50, v7
    v_dot2c_f32_bf16 v210, v51, v6
    v_dot2c_f32_bf16 v211, v51, v7
    s_waitcnt vmcnt(12)
    v_dot2c_f32_bf16 v204, v52, v6
    v_dot2c_f32_bf16 v205, v52, v7
    v_dot2c_f32_bf16 v206, v53, v6
    v_dot2c_f32_bf16 v207, v53, v7
    v_dot2c_f32_bf16 v208, v54, v6
    v_dot2c_f32_bf16 v209, v54, v7
    v_dot2c_f32_bf16 v210, v55, v6
    v_dot2c_f32_bf16 v211, v55, v7
    s_waitcnt vmcnt(11)
    v_dot2c_f32_bf16 v204, v56, v6
    v_dot2c_f32_bf16 v205, v56, v7
    v_dot2c_f32_bf16 v206, v57, v6
    v_dot2c_f32_bf16 v207, v57, v7
    v_dot2c_f32_bf16 v208, v58, v6
    v_dot2c_f32_bf16 v209, v58, v7
    v_dot2c_f32_bf16 v210, v59, v6
    v_dot2c_f32_bf16 v211, v59, v7
    s_waitcnt vmcnt(10)
    v_dot2c_f32_bf16 v204, v60, v6
    v_dot2c_f32_bf16 v205, v60, v7
    v_dot2c_f32_bf16 v206, v61, v6
    v_dot2c_f32_bf16 v207, v61, v7
    v_dot2c_f32_bf16 v208, v62, v6
    v_dot2c_f32_bf16 v209, v62, v7
    v_dot2c_f32_bf16 v210, v63, v6
    v_dot2c_f32_bf16 v211, v63, v7
    s_waitcnt vmcnt(9)
    v_dot2c_f32_bf16 v204, v64, v6
    v_dot2c_f32_bf16 v205, v64, v7
    v_dot2c_f32_bf16 v206, v65, v6
    v_dot2c_f32_bf16 v207, v65, v7
    v_dot2c_f32_bf16 v208, v66, v6
    v_dot2c_f32_bf16 v209, v66, v7
    v_dot2c_f32_bf16 v210, v67, v6
    v_dot2c_f32_bf16 v211, v67, v7
    s_waitcnt vmcnt(8)
    v_dot2c_f32_bf16 v204, v68, v6
    v_dot2c_f32_bf16 v205, v68, v7
    v_dot2c_f32_bf16 v206, v69, v6
    v_dot2c_f32_bf16 v207, v69, v7
    v_dot2c_f32_bf16 v208, v70, v6
    v_dot2c_f32_bf16 v209, v70, v7
    v_dot2c_f32_bf16 v210, v71, v6
    v_dot2c_f32_bf16 v211, v71, v7
    s_waitcnt vmcnt(7)
    v_dot2c_f32_bf16 v204, v168, v6
    v_dot2c_f32_bf16 v205, v168, v7
    v_dot2c_f32_bf16 v206, v169, v6
    v_dot2c_f32_bf16 v207, v169, v7
    v_dot2c_f32_bf16 v208, v170, v6
    v_dot2c_f32_bf16 v209, v170, v7
    v_dot2c_f32_bf16 v210, v171, v6
    v_dot2c_f32_bf16 v211, v171, v7
    s_waitcnt vmcnt(6)
    v_dot2c_f32_bf16 v204, v172, v6
    v_dot2c_f32_bf16 v205, v172, v7
    v_dot2c_f32_bf16 v206, v173, v6
    v_dot2c_f32_bf16 v207, v173, v7
    v_dot2c_f32_bf16 v208, v174, v6
    v_dot2c_f32_bf16 v209, v174, v7
    v_dot2c_f32_bf16 v210, v175, v6
    v_dot2c_f32_bf16 v211, v175, v7
    s_waitcnt vmcnt(5)
    v_dot2c_f32_bf16 v204, v176, v6
    v_dot2c_f32_bf16 v205, v176, v7
    v_dot2c_f32_bf16 v206, v177, v6
    v_dot2c_f32_bf16 v207, v177, v7
    v_dot2c_f32_bf16 v208, v178, v6
    v_dot2c_f32_bf16 v209, v178, v7
    v_dot2c_f32_bf16 v210, v179, v6
    v_dot2c_f32_bf16 v211, v179, v7
    s_waitcnt vmcnt(4)
    v_dot2c_f32_bf16 v204, v180, v6
    v_dot2c_f32_bf16 v205, v180, v7
    v_dot2c_f32_bf16 v206, v181, v6
    v_dot2c_f32_bf16 v207, v181, v7
    v_dot2c_f32_bf16 v208, v182, v6
    v_dot2c_f32_bf16 v209, v182, v7
    v_dot2c_f32_bf16 v210, v183, v6
    v_dot2c_f32_bf16 v211, v183, v7
    s_waitcnt vmcnt(3)
    v_dot2c_f32_bf16 v204, v184, v6
    v_dot2c_f32_bf16 v205, v184, v7
    v_dot2c_f32_bf16 v206, v185, v6
    v_dot2c_f32_bf16 v207, v185, v7
    v_dot2c_f32_bf16 v208, v186, v6
    v_dot2c_f32_bf16 v209, v186, v7
    v_dot2c_f32_bf16 v210, v187, v6
    v_dot2c_f32_bf16 v211, v187, v7
    s_waitcnt vmcnt(2)
    v_dot2c_f32_bf16 v204, v188, v6
    v_dot2c_f32_bf16 v205, v188, v7
    v_dot2c_f32_bf16 v206, v189, v6
    v_dot2c_f32_bf16 v207, v189, v7
    v_dot2c_f32_bf16 v208, v190, v6
    v_dot2c_f32_bf16 v209, v190, v7
    v_dot2c_f32_bf16 v210, v191, v6
    v_dot2c_f32_bf16 v211, v191, v7
    s_waitcnt vmcnt(1)
    v_dot2c_f32_bf16 v204, v192, v6
    v_dot2c_f32_bf16 v205, v192, v7
    v_dot2c_f32_bf16 v206, v193, v6
    v_dot2c_f32_bf16 v207, v193, v7
    v_dot2c_f32_bf16 v208, v194, v6
    v_dot2c_f32_bf16 v209, v194, v7
    v_dot2c_f32_bf16 v210, v195, v6
    v_dot2c_f32_bf16 v211, v195, v7
    s_waitcnt vmcnt(0)
    v_dot2c_f32_bf16 v204, v196, v6
    v_dot2c_f32_bf16 v205, v196, v7
    v_dot2c_f32_bf16 v206, v197, v6
    v_dot2c_f32_bf16 v207, v197, v7
    v_dot2c_f32_bf16 v208, v198, v6
    v_dot2c_f32_bf16 v209, v198, v7
    v_dot2c_f32_bf16 v210, v199, v6
    v_dot2c_f32_bf16 v211, v199, v7
    v_cvt_pk_bf16_f32 v212, v204, v205
    v_cvt_pk_bf16_f32 v213, v206, v207
    v_cvt_pk_bf16_f32 v214, v208, v209
    v_cvt_pk_bf16_f32 v215, v210, v211
    ds_write_b64 v72, v[212:213]
    ds_write_b64 v73, v[214:215]
    s_cmp_lg_u32 s3, 0
    s_cbranch_scc1 Lw0_21
    s_waitcnt vmcnt(0)
    v_cmp_ne_u64 vcc, s[54:55], v[236:237]
    s_cbranch_vccnz Ls_18
Lb_19:
Lw0_21:
    s_waitcnt lgkmcnt(0)
    s_barrier
    ds_read_b64_tr_b16 v[132:133], v79 offset:0
    buffer_load_dwordx4 a[140:143], v16, s[12:15], s63 offen offset:0 sc1
    ds_read_b64_tr_b16 v[134:135], v79 offset:256
    ds_read_b64_tr_b16 v[128:129], v78 offset:0
    ds_read_b64_tr_b16 v[130:131], v78 offset:256
    ds_read_b64_tr_b16 v[140:141], v79 offset:512
    ds_read_b64_tr_b16 v[142:143], v79 offset:768
    ds_read_b64_tr_b16 v[136:137], v78 offset:512
    ds_read_b64_tr_b16 v[138:139], v78 offset:768
    s_waitcnt lgkmcnt(4)
    v_mfma_f32_32x32x16_bf16 v[208:223], v[132:135], v[104:107], 0
    ds_read_b64_tr_b16 v[148:149], v79 offset:1024
    ds_read_b64_tr_b16 v[150:151], v79 offset:1280
    v_mfma_f32_32x32x16_bf16 v[192:207], v[128:131], v[104:107], 0
    buffer_load_dwordx4 a[144:147], v16, s[12:15], s63 offen offset:1024 sc1
    ds_read_b64_tr_b16 v[144:145], v78 offset:1024
    ds_read_b64_tr_b16 v[146:147], v78 offset:1280
    s_waitcnt lgkmcnt(4)
    v_mfma_f32_32x32x16_bf16 v[208:223], v[140:143], v[108:111], v[208:223]
    ds_read_b64_tr_b16 v[156:157], v79 offset:1536
    ds_read_b64_tr_b16 v[158:159], v79 offset:1792
    v_mfma_f32_32x32x16_bf16 v[192:207], v[136:139], v[108:111], v[192:207]
    buffer_load_dwordx4 a[148:151], v16, s[12:15], s63 offen offset:2048 sc1
    ds_read_b64_tr_b16 v[152:153], v78 offset:1536
    ds_read_b64_tr_b16 v[154:155], v78 offset:1792
    s_waitcnt lgkmcnt(4)
    v_mfma_f32_32x32x16_bf16 v[208:223], v[148:151], v[112:115], v[208:223]
    ds_read_b64_tr_b16 v[164:165], v79 offset:2048
    ds_read_b64_tr_b16 v[166:167], v79 offset:2304
    v_mfma_f32_32x32x16_bf16 v[192:207], v[144:147], v[112:115], v[192:207]
    buffer_load_dwordx4 a[152:155], v16, s[12:15], s63 offen offset:3072 sc1
    s_add_u32 s63, s63, 4096
    ds_read_b64_tr_b16 v[160:161], v78 offset:2048
    ds_read_b64_tr_b16 v[162:163], v78 offset:2304
    s_waitcnt lgkmcnt(4)
    v_mfma_f32_32x32x16_bf16 v[208:223], v[156:159], v[116:119], v[208:223]
    v_mfma_f32_32x32x16_bf16 v[192:207], v[152:155], v[116:119], v[192:207]
    buffer_load_dwordx4 a[156:159], v16, s[12:15], s63 offen offset:0 sc1
    s_waitcnt lgkmcnt(0)
    v_mfma_f32_32x32x16_bf16 v[208:223], v[164:167], v[120:123], v[208:223]
    v_mfma_f32_32x32x16_bf16 v[192:207], v[160:163], v[120:123], v[192:207]
    buffer_load_dwordx4 a[160:163], v16, s[12:15], s63 offen offset:1024 sc1
    v_accvgpr_read_b32 v15, a249
    s_nop 8
    v_add_f32 v6, 0x358637bd, v212
    v_rcp_f32 v6, v6
    s_nop 0
    v_pk_mul_f32 v[192:193], v[192:193], v[6:7] op_sel_hi:[1,0]
    v_cvt_pk_bf16_f32 v224, v192, v193
    v_pk_mul_f32 v[194:195], v[194:195], v[6:7] op_sel_hi:[1,0]
    v_cvt_pk_bf16_f32 v225, v194, v195
    v_pk_mul_f32 v[196:197], v[196:197], v[6:7] op_sel_hi:[1,0]
    v_cvt_pk_bf16_f32 v226, v196, v197
    v_pk_mul_f32 v[198:199], v[198:199], v[6:7] op_sel_hi:[1,0]
    v_cvt_pk_bf16_f32 v227, v198, v199
    buffer_load_dwordx4 a[164:167], v16, s[12:15], s63 offen offset:2048 sc1
    v_pk_mul_f32 v[200:201], v[200:201], v[6:7] op_sel_hi:[1,0]
    v_cvt_pk_bf16_f32 v228, v200, v201
    v_pk_mul_f32 v[202:203], v[202:203], v[6:7] op_sel_hi:[1,0]
    v_cvt_pk_bf16_f32 v229, v202, v203
    v_pk_mul_f32 v[204:205], v[204:205], v[6:7] op_sel_hi:[1,0]
    v_cvt_pk_bf16_f32 v230, v204, v205
    v_pk_mul_f32 v[206:207], v[206:207], v[6:7] op_sel_hi:[1,0]
    v_cvt_pk_bf16_f32 v231, v206, v207
    v_pk_mul_f32 v[208:209], v[208:209], v[6:7] op_sel_hi:[1,0]
    v_cvt_pk_bf16_f32 v232, v208, v209
    v_pk_mul_f32 v[210:211], v[210:211], v[6:7] op_sel_hi:[1,0]
    v_cvt_pk_bf16_f32 v233, v210, v211
    buffer_load_dwordx4 a[168:171], v16, s[12:15], s63 offen offset:3072 sc1
    s_add_u32 s63, s63, 4096
    buffer_load_dwordx4 a[172:175], v16, s[12:15], s63 offen offset:0 sc1
    buffer_load_dwordx4 a[176:179], v16, s[12:15], s63 offen offset:1024 sc1
    buffer_store_dwordx4 v[224:227], v81, s[12:15], s80 offen sc1
    buffer_store_dwordx4 v[228:231], v81, s[12:15], s80 offen offset:256 sc1
    buffer_store_dwordx2 v[232:233], v82, s[12:15], s80 offen offset:512 sc1
    buffer_load_dwordx4 a[180:183], v16, s[12:15], s63 offen offset:2048 sc1
    buffer_load_dwordx4 a[184:187], v16, s[12:15], s63 offen offset:3072 sc1
    s_add_u32 s63, s63, 4096
    buffer_load_dwordx4 a[188:191], v16, s[12:15], s63 offen offset:0 sc1
    buffer_load_dwordx4 a[192:195], v16, s[12:15], s63 offen offset:1024 sc1
    buffer_load_dwordx4 a[196:199], v16, s[12:15], s63 offen offset:2048 sc1
    s_add_u32 s49, s3, 0
    s_and_b32 s49, s49, 3
    s_mul_i32 s50, s49, 20480
    v_add_u32 v36, s50, v16
    s_mul_i32 s50, s49, 15360
    s_add_u32 s50, s50, 98528
    v_add_u32 v47, s50, v16
    s_add_u32 s49, s3, 1
    s_and_b32 s49, s49, 3
    s_mul_i32 s50, s49, 20480
    v_add_u32 v37, s50, v16
    s_mul_i32 s50, s49, 15360
    s_add_u32 s50, s50, 98528
    v_add_u32 v44, s50, v16
    s_add_u32 s49, s3, 2
    s_and_b32 s49, s49, 3
    s_mul_i32 s50, s49, 20480
    v_add_u32 v38, s50, v16
    s_mul_i32 s50, s49, 15360
    s_add_u32 s50, s50, 103648
    v_add_u32 v45, s50, v16
    s_add_u32 s49, s3, 3
    s_and_b32 s49, s49, 3
    s_mul_i32 s50, s49, 20480
    v_add_u32 v39, s50, v16
    s_mul_i32 s50, s49, 15360
    s_add_u32 s50, s50, 108768
    v_add_u32 v46, s50, v16
    s_mul_i32 s49, s3, 15360
    s_sub_u32 s84, s84, s49
    s_add_u32 s58, s84, 4096
    s_waitcnt vmcnt(5)
    s_barrier
    s_cmp_lg_u32 s3, 0
    s_cbranch_scc1 Lw0_23
    v_mov_b32 v30, s54
    v_mov_b32 v31, s55
    s_mov_b64 exec, 1
    s_cmp_eq_u32 s98, 1
    s_cbranch_scc1 Lf_24
    buffer_store_dwordx2 v[30:31], off, s[12:15], s73 sc1
    s_branch Lg_25
Lf_24:
    buffer_store_dwordx2 v[30:31], off, s[12:15], s73
Lg_25:
    s_mov_b64 exec, -1
Lw0_23:
    buffer_load_dwordx4 a[200:203], v16, s[12:15], s63 offen offset:3072 sc1
    s_add_u32 s63, s63, 4096
    buffer_load_dwordx4 a[204:207], v16, s[12:15], s63 offen offset:0 sc1
    buffer_load_dwordx4 a[208:211], v16, s[12:15], s63 offen offset:1024 sc1
    buffer_load_dwordx4 a[212:215], v16, s[12:15], s63 offen offset:2048 sc1
    buffer_load_dwordx4 a[216:219], v16, s[12:15], s63 offen offset:3072 sc1
    s_add_u32 s63, s63, 4096
    buffer_load_dwordx4 a[220:223], v16, s[12:15], s63 offen offset:0 sc1
    buffer_load_dwordx4 a[224:227], v16, s[12:15], s63 offen offset:1024 sc1
    buffer_load_dwordx4 a[228:231], v16, s[12:15], s63 offen offset:2048 sc1
    buffer_load_dwordx4 a[232:235], v16, s[12:15], s63 offen offset:3072 sc1
    s_add_u32 s63, s63, 4096
    buffer_load_dwordx4 a[236:239], v16, s[12:15], s63 offen offset:0 sc1
    s_add_u32 s52, s97, 0
    s_mov_b32 s53, 200000
Lp_26:
    buffer_load_dwordx2 v[2:3], v18, s[12:15], s52 offen sc1
    s_waitcnt vmcnt(0)
    v_cmp_ne_u64 vcc, s[54:55], v[2:3]
    s_cbranch_vccz Ld_27
    s_sleep 1
    s_sub_u32 s53, s53, 1
    s_cmp_gt_i32 s53, 0
    s_cbranch_scc1 Lp_26
Ld_27:
    s_waitcnt vmcnt(0)
    buffer_load_dwordx4 v[208:211], v37, s[12:15], s84 offen offset:0 sc1
    buffer_load_dwordx4 v[212:215], v37, s[12:15], s84 offen offset:1024 sc1
    buffer_load_dwordx4 v[216:219], v37, s[12:15], s84 offen offset:2048 sc1
    buffer_load_dwordx4 v[220:223], v37, s[12:15], s84 offen offset:3072 sc1
    buffer_load_dwordx4 v[224:227], v37, s[12:15], s58 offen offset:0 sc1
    buffer_load_dwordx4 v[228:231], v38, s[12:15], s84 offen offset:0 sc1
    buffer_load_dwordx4 v[232:235], v38, s[12:15], s84 offen offset:1024 sc1
    buffer_load_dwordx4 v[236:239], v38, s[12:15], s84 offen offset:2048 sc1
    v_accvgpr_read_b32 v4, a245
    v_accvgpr_read_b32 v5, a246
    v_permlane16_swap_b32 v20, v22
    v_permlane16_swap_b32 v21, v23
    v_permlane16_swap_b32 v24, v26
    v_permlane16_swap_b32 v25, v27
    v_lshlrev_b32 v104, 16, v20
    v_and_b32 v105, 0xffff0000, v20
    v_lshlrev_b32 v106, 16, v21
    v_and_b32 v107, 0xffff0000, v21
    v_lshlrev_b32 v108, 16, v22
    v_and_b32 v109, 0xffff0000, v22
    v_lshlrev_b32 v110, 16, v23
    v_and_b32 v111, 0xffff0000, v23
    v_lshlrev_b32 v112, 16, v24
    v_and_b32 v113, 0xffff0000, v24
    v_lshlrev_b32 v114, 16, v25
    v_and_b32 v115, 0xffff0000, v25
    v_lshlrev_b32 v116, 16, v26
    v_and_b32 v117, 0xffff0000, v26
    v_lshlrev_b32 v118, 16, v27
    v_and_b32 v119, 0xffff0000, v27
    v_lshlrev_b32 v120, 16, v28
    v_and_b32 v121, 0xffff0000, v28
    v_lshlrev_b32 v122, 16, v29
    v_and_b32 v123, 0xffff0000, v29
    s_waitcnt vmcnt(7)
    v_mfma_f32_16x16x32_bf16 v[148:151], a[140:143], v[208:211], 0
    v_mfma_f32_16x16x32_bf16 v[152:155], a[144:147], v[208:211], 0
    buffer_load_dwordx4 v[240:243], v38, s[12:15], s84 offen offset:3072 sc1
    v_mfma_f32_16x16x32_bf16 v[156:159], a[148:151], v[208:211], 0
    v_mfma_f32_16x16x32_bf16 v[160:163], a[152:155], v[208:211], 0
    v_mfma_f32_16x16x32_bf16 v[164:167], a[156:159], v[208:211], 0
    s_waitcnt vmcnt(7)
    v_mfma_f32_16x16x32_bf16 v[148:151], a[160:163], v[212:215], v[148:151]
    v_mfma_f32_16x16x32_bf16 v[152:155], a[164:167], v[212:215], v[152:155]
    buffer_load_dwordx4 v[244:247], v38, s[12:15], s58 offen offset:0 sc1
    v_mfma_f32_16x16x32_bf16 v[156:159], a[168:171], v[212:215], v[156:159]
    v_mfma_f32_16x16x32_bf16 v[160:163], a[172:175], v[212:215], v[160:163]
    v_mfma_f32_16x16x32_bf16 v[164:167], a[176:179], v[212:215], v[164:167]
    s_waitcnt vmcnt(7)
    v_mfma_f32_16x16x32_bf16 v[148:151], a[180:183], v[216:219], v[148:151]
    v_mfma_f32_16x16x32_bf16 v[152:155], a[184:187], v[216:219], v[152:155]
    buffer_load_dwordx4 v[248:251], v39, s[12:15], s84 offen offset:0 sc1
    v_mfma_f32_16x16x32_bf16 v[156:159], a[188:191], v[216:219], v[156:159]
    v_mfma_f32_16x16x32_bf16 v[160:163], a[192:195], v[216:219], v[160:163]
    v_mfma_f32_16x16x32_bf16 v[164:167], a[196:199], v[216:219], v[164:167]
    s_waitcnt vmcnt(7)
    v_mfma_f32_16x16x32_bf16 v[148:151], a[200:203], v[220:223], v[148:151]
    v_mfma_f32_16x16x32_bf16 v[152:155], a[204:207], v[220:223], v[152:155]
    buffer_load_dwordx4 v[252:255], v39, s[12:15], s84 offen offset:1024 sc1
    v_mfma_f32_16x16x32_bf16 v[156:159], a[208:211], v[220:223], v[156:159]
    v_mfma_f32_16x16x32_bf16 v[160:163], a[212:215], v[220:223], v[160:163]
    v_mfma_f32_16x16x32_bf16 v[164:167], a[216:219], v[220:223], v[164:167]
    s_waitcnt vmcnt(7)
    v_mfma_f32_16x16x32_bf16 v[148:151], a[220:223], v[224:227], v[148:151]
    v_mfma_f32_16x16x32_bf16 v[152:155], a[224:227], v[224:227], v[152:155]
    buffer_load_dwordx4 v[48:51], v39, s[12:15], s84 offen offset:2048 sc1
    v_mfma_f32_16x16x32_bf16 v[156:159], a[228:231], v[224:227], v[156:159]
    v_mfma_f32_16x16x32_bf16 v[160:163], a[232:235], v[224:227], v[160:163]
    v_mfma_f32_16x16x32_bf16 v[164:167], a[236:239], v[224:227], v[164:167]
    s_waitcnt vmcnt(7)
    v_mfma_f32_16x16x32_bf16 v[168:171], a[140:143], v[228:231], 0
    v_mfma_f32_16x16x32_bf16 v[172:175], a[144:147], v[228:231], 0
    buffer_load_dwordx4 v[52:55], v39, s[12:15], s84 offen offset:3072 sc1
    v_mfma_f32_16x16x32_bf16 v[176:179], a[148:151], v[228:231], 0
    ds_write_b128 v44, v[148:151] offset:0
    v_mfma_f32_16x16x32_bf16 v[180:183], a[152:155], v[228:231], 0
    ds_write_b128 v44, v[152:155] offset:1024
    v_mfma_f32_16x16x32_bf16 v[184:187], a[156:159], v[228:231], 0
    ds_write_b128 v44, v[156:159] offset:2048
    s_waitcnt vmcnt(7)
    v_mfma_f32_16x16x32_bf16 v[168:171], a[160:163], v[232:235], v[168:171]
    ds_write_b128 v44, v[160:163] offset:3072
    v_mfma_f32_16x16x32_bf16 v[172:175], a[164:167], v[232:235], v[172:175]
    buffer_load_dwordx4 v[56:59], v39, s[12:15], s58 offen offset:0 sc1
    ds_write_b128 v44, v[164:167] offset:4096
    v_mfma_f32_16x16x32_bf16 v[176:179], a[168:171], v[232:235], v[176:179]
    v_mfma_f32_16x16x32_bf16 v[180:183], a[172:175], v[232:235], v[180:183]
    v_mfma_f32_16x16x32_bf16 v[184:187], a[176:179], v[232:235], v[184:187]
    s_waitcnt vmcnt(7)
    v_mfma_f32_16x16x32_bf16 v[168:171], a[180:183], v[236:239], v[168:171]
    v_mfma_f32_16x16x32_bf16 v[172:175], a[184:187], v[236:239], v[172:175]
    buffer_load_dwordx4 v[60:63], v36, s[12:15], s84 offen offset:0 sc1
    v_mfma_f32_16x16x32_bf16 v[176:179], a[188:191], v[236:239], v[176:179]
    v_mfma_f32_16x16x32_bf16 v[180:183], a[192:195], v[236:239], v[180:183]
    v_mfma_f32_16x16x32_bf16 v[184:187], a[196:199], v[236:239], v[184:187]
    s_waitcnt vmcnt(7)
    v_mfma_f32_16x16x32_bf16 v[168:171], a[200:203], v[240:243], v[168:171]
    v_mfma_f32_16x16x32_bf16 v[172:175], a[204:207], v[240:243], v[172:175]
    buffer_load_dwordx4 v[64:67], v36, s[12:15], s84 offen offset:1024 sc1
    v_mfma_f32_16x16x32_bf16 v[176:179], a[208:211], v[240:243], v[176:179]
    v_mfma_f32_16x16x32_bf16 v[180:183], a[212:215], v[240:243], v[180:183]
    v_mfma_f32_16x16x32_bf16 v[184:187], a[216:219], v[240:243], v[184:187]
    s_waitcnt vmcnt(7)
    v_mfma_f32_16x16x32_bf16 v[168:171], a[220:223], v[244:247], v[168:171]
    v_mfma_f32_16x16x32_bf16 v[172:175], a[224:227], v[244:247], v[172:175]
    buffer_load_dwordx4 v[68:71], v36, s[12:15], s84 offen offset:2048 sc1
    v_mfma_f32_16x16x32_bf16 v[176:179], a[228:231], v[244:247], v[176:179]
    v_mfma_f32_16x16x32_bf16 v[180:183], a[232:235], v[244:247], v[180:183]
    v_mfma_f32_16x16x32_bf16 v[184:187], a[236:239], v[244:247], v[184:187]
    s_waitcnt vmcnt(7)
    v_mfma_f32_16x16x32_bf16 v[188:191], a[140:143], v[248:251], 0
    v_mfma_f32_16x16x32_bf16 v[192:195], a[144:147], v[248:251], 0
    buffer_load_dwordx4 v[72:75], v36, s[12:15], s84 offen offset:3072 sc1
    v_mfma_f32_16x16x32_bf16 v[196:199], a[148:151], v[248:251], 0
    ds_write_b128 v45, v[168:171] offset:0
    v_mfma_f32_16x16x32_bf16 v[200:203], a[152:155], v[248:251], 0
    ds_write_b128 v45, v[172:175] offset:1024
    v_mfma_f32_16x16x32_bf16 v[204:207], a[156:159], v[248:251], 0
    ds_write_b128 v45, v[176:179] offset:2048
    s_waitcnt vmcnt(7)
    v_mfma_f32_16x16x32_bf16 v[188:191], a[160:163], v[252:255], v[188:191]
    ds_write_b128 v45, v[180:183] offset:3072
    v_mfma_f32_16x16x32_bf16 v[192:195], a[164:167], v[252:255], v[192:195]
    buffer_load_dwordx4 v[76:79], v36, s[12:15], s58 offen offset:0 sc1
    ds_write_b128 v45, v[184:187] offset:4096
    v_mfma_f32_16x16x32_bf16 v[196:199], a[168:171], v[252:255], v[196:199]
    v_mfma_f32_16x16x32_bf16 v[200:203], a[172:175], v[252:255], v[200:203]
    v_mfma_f32_16x16x32_bf16 v[204:207], a[176:179], v[252:255], v[204:207]
    s_waitcnt vmcnt(7)
    v_mfma_f32_16x16x32_bf16 v[188:191], a[180:183], v[48:51], v[188:191]
    v_mfma_f32_16x16x32_bf16 v[192:195], a[184:187], v[48:51], v[192:195]
    s_add_u32 m0, s90, 24640
    s_nop 0
    buffer_load_dwordx4 v10, s[32:35], s89 offen offset:0 lds
    v_mfma_f32_16x16x32_bf16 v[196:199], a[188:191], v[48:51], v[196:199]
    v_mfma_f32_16x16x32_bf16 v[200:203], a[192:195], v[48:51], v[200:203]
    v_mfma_f32_16x16x32_bf16 v[204:207], a[196:199], v[48:51], v[204:207]
    s_waitcnt vmcnt(7)
    v_mfma_f32_16x16x32_bf16 v[188:191], a[200:203], v[52:55], v[188:191]
    v_mfma_f32_16x16x32_bf16 v[192:195], a[204:207], v[52:55], v[192:195]
    buffer_load_dwordx4 v11, s[32:35], s89 offen offset:1024 lds
    v_mfma_f32_16x16x32_bf16 v[196:199], a[208:211], v[52:55], v[196:199]
    v_mfma_f32_16x16x32_bf16 v[200:203], a[212:215], v[52:55], v[200:203]
    v_mfma_f32_16x16x32_bf16 v[204:207], a[216:219], v[52:55], v[204:207]
    s_waitcnt vmcnt(7)
    v_mfma_f32_16x16x32_bf16 v[188:191], a[220:223], v[56:59], v[188:191]
    v_mfma_f32_16x16x32_bf16 v[192:195], a[224:227], v[56:59], v[192:195]
    buffer_load_dwordx4 v12, s[32:35], s89 offen offset:2048 lds
    s_add_u32 s89, s89, 98304
    v_mfma_f32_16x16x32_bf16 v[196:199], a[228:231], v[56:59], v[196:199]
    v_mfma_f32_16x16x32_bf16 v[200:203], a[232:235], v[56:59], v[200:203]
    v_mfma_f32_16x16x32_bf16 v[204:207], a[236:239], v[56:59], v[204:207]
    s_waitcnt vmcnt(7)
    v_mfma_f32_16x16x32_bf16 v[128:131], a[140:143], v[60:63], v[104:107]
    v_mfma_f32_16x16x32_bf16 v[132:135], a[144:147], v[60:63], v[108:111]
    s_add_u32 m0, s90, 36960
    s_nop 0
    buffer_load_dwordx4 v10, s[32:35], s89 offen offset:0 lds
    v_mfma_f32_16x16x32_bf16 v[136:139], a[148:151], v[60:63], v[112:115]
    ds_write_b128 v46, v[188:191] offset:0
    v_mfma_f32_16x16x32_bf16 v[140:143], a[152:155], v[60:63], v[116:119]
    ds_write_b128 v46, v[192:195] offset:1024
    v_mfma_f32_16x16x32_bf16 v[144:147], a[156:159], v[60:63], v[120:123]
    ds_write_b128 v46, v[196:199] offset:2048
    s_waitcnt vmcnt(7)
    v_mfma_f32_16x16x32_bf16 v[128:131], a[160:163], v[64:67], v[128:131]
    ds_write_b128 v46, v[200:203] offset:3072
    v_mfma_f32_16x16x32_bf16 v[132:135], a[164:167], v[64:67], v[132:135]
    buffer_load_dwordx4 v11, s[32:35], s89 offen offset:1024 lds
    ds_write_b128 v46, v[204:207] offset:4096
    v_mfma_f32_16x16x32_bf16 v[136:139], a[168:171], v[64:67], v[136:139]
    v_mfma_f32_16x16x32_bf16 v[140:143], a[172:175], v[64:67], v[140:143]
    v_mfma_f32_16x16x32_bf16 v[144:147], a[176:179], v[64:67], v[144:147]
    s_waitcnt vmcnt(7)
    v_mfma_f32_16x16x32_bf16 v[128:131], a[180:183], v[68:71], v[128:131]
    v_mfma_f32_16x16x32_bf16 v[132:135], a[184:187], v[68:71], v[132:135]
    buffer_load_dwordx4 v12, s[32:35], s89 offen offset:2048 lds
    s_add_u32 s89, s89, 98304
    v_mfma_f32_16x16x32_bf16 v[136:139], a[188:191], v[68:71], v[136:139]
    v_mfma_f32_16x16x32_bf16 v[140:143], a[192:195], v[68:71], v[140:143]
    v_mfma_f32_16x16x32_bf16 v[144:147], a[196:199], v[68:71], v[144:147]
    s_waitcnt vmcnt(7) lgkmcnt(0)
    s_barrier
    v_mfma_f32_16x16x32_bf16 v[128:131], a[200:203], v[72:75], v[128:131]
    ds_read_b128 v[148:151], v47 offset:0
    ds_read_b128 v[152:155], v47 offset:1024
    v_mfma_f32_16x16x32_bf16 v[132:135], a[204:207], v[72:75], v[132:135]
    s_add_u32 m0, s90, 73920
    s_nop 0
    buffer_load_dwordx4 v10, s[32:35], s89 offen offset:0 lds
    ds_read_b128 v[156:159], v47 offset:2048
    ds_read_b128 v[160:163], v47 offset:3072
    v_mfma_f32_16x16x32_bf16 v[136:139], a[208:211], v[72:75], v[136:139]
    ds_read_b128 v[164:167], v47 offset:4096
    ds_read_b128 v[168:171], v47 offset:5120
    v_mfma_f32_16x16x32_bf16 v[140:143], a[212:215], v[72:75], v[140:143]
    ds_read_b128 v[172:175], v47 offset:6144
    ds_read_b128 v[176:179], v47 offset:7168
    v_mfma_f32_16x16x32_bf16 v[144:147], a[216:219], v[72:75], v[144:147]
    ds_read_b128 v[180:183], v47 offset:8192
    ds_read_b128 v[184:187], v47 offset:9216
    s_waitcnt vmcnt(7)
    v_mfma_f32_16x16x32_bf16 v[128:131], a[220:223], v[76:79], v[128:131]
    ds_read_b128 v[188:191], v47 offset:10240
    ds_read_b128 v[192:195], v47 offset:11264
    v_mfma_f32_16x16x32_bf16 v[132:135], a[224:227], v[76:79], v[132:135]
    buffer_load_dwordx4 v11, s[32:35], s89 offen offset:1024 lds
    ds_read_b128 v[196:199], v47 offset:12288
    ds_read_b128 v[200:203], v47 offset:13312
    v_mfma_f32_16x16x32_bf16 v[136:139], a[228:231], v[76:79], v[136:139]
    ds_read_b128 v[204:207], v47 offset:14336
    v_mfma_f32_16x16x32_bf16 v[140:143], a[232:235], v[76:79], v[140:143]
    v_mfma_f32_16x16x32_bf16 v[144:147], a[236:239], v[76:79], v[144:147]
    buffer_load_dwordx4 v12, s[32:35], s89 offen offset:2048 lds
    s_add_u32 s89, s89, 98304
    s_waitcnt lgkmcnt(10)
    v_pk_add_f32 v[128:129], v[128:129], v[148:149]
    v_pk_add_f32 v[130:131], v[130:131], v[150:151]
    v_pk_add_f32 v[132:133], v[132:133], v[152:153]
    v_pk_add_f32 v[134:135], v[134:135], v[154:155]
    v_pk_add_f32 v[136:137], v[136:137], v[156:157]
    v_pk_add_f32 v[138:139], v[138:139], v[158:159]
    v_pk_add_f32 v[140:141], v[140:141], v[160:161]
    v_pk_add_f32 v[142:143], v[142:143], v[162:163]
    v_pk_add_f32 v[144:145], v[144:145], v[164:165]
    v_pk_add_f32 v[146:147], v[146:147], v[166:167]
    s_waitcnt lgkmcnt(5)
    v_pk_add_f32 v[128:129], v[128:129], v[168:169]
    v_pk_add_f32 v[130:131], v[130:131], v[170:171]
    v_pk_add_f32 v[132:133], v[132:133], v[172:173]
    v_pk_add_f32 v[134:135], v[134:135], v[174:175]
    v_pk_add_f32 v[136:137], v[136:137], v[176:177]
    v_pk_add_f32 v[138:139], v[138:139], v[178:179]
    v_pk_add_f32 v[140:141], v[140:141], v[180:181]
    v_pk_add_f32 v[142:143], v[142:143], v[182:183]
    v_pk_add_f32 v[144:145], v[144:145], v[184:185]
    v_pk_add_f32 v[146:147], v[146:147], v[186:187]
    s_waitcnt lgkmcnt(0)
    v_pk_add_f32 v[128:129], v[128:129], v[188:189]
    v_pk_add_f32 v[130:131], v[130:131], v[190:191]
    v_pk_add_f32 v[132:133], v[132:133], v[192:193]
    v_pk_add_f32 v[134:135], v[134:135], v[194:195]
    v_pk_add_f32 v[136:137], v[136:137], v[196:197]
    v_pk_add_f32 v[138:139], v[138:139], v[198:199]
    v_pk_add_f32 v[140:141], v[140:141], v[200:201]
    v_pk_add_f32 v[142:143], v[142:143], v[202:203]
    v_pk_add_f32 v[144:145], v[144:145], v[204:205]
    v_pk_add_f32 v[146:147], v[146:147], v[206:207]
    v_cvt_pk_bf16_f32 v148, v128, v129
    v_cvt_pk_bf16_f32 v149, v130, v131
    v_cvt_pk_bf16_f32 v150, v132, v133
    v_cvt_pk_bf16_f32 v151, v134, v135
    v_cvt_pk_bf16_f32 v152, v136, v137
    v_cvt_pk_bf16_f32 v153, v138, v139
    v_cvt_pk_bf16_f32 v154, v140, v141
    v_cvt_pk_bf16_f32 v155, v142, v143
    v_cvt_pk_bf16_f32 v120, v144, v145
    v_cvt_pk_bf16_f32 v121, v146, v147
    v_mov_b32 v112, v148
    v_mov_b32 v113, v149
    v_mov_b32 v114, v150
    v_mov_b32 v115, v151
    v_mov_b32 v116, v152
    v_mov_b32 v117, v153
    v_mov_b32 v118, v154
    v_mov_b32 v119, v155
    v_permlane16_swap_b32 v148, v150
    v_permlane16_swap_b32 v149, v151
    v_permlane16_swap_b32 v152, v154
    v_permlane16_swap_b32 v153, v155
    buffer_store_dwordx2 v[120:121], v5, s[12:15], s82 offen sc1
    buffer_store_dwordx4 v[148:151], v4, s[12:15], s81 offen offset:0 sc1
    buffer_store_dwordx4 v[152:155], v4, s[12:15], s81 offen offset:2048 sc1
    s_barrier
    v_lshlrev_b32 v128, 16, v112
    v_and_b32 v129, 0xffff0000, v112
    v_lshlrev_b32 v130, 16, v113
    v_and_b32 v131, 0xffff0000, v113
    v_lshlrev_b32 v132, 16, v114
    v_and_b32 v133, 0xffff0000, v114
    v_lshlrev_b32 v134, 16, v115
    v_and_b32 v135, 0xffff0000, v115
    v_lshlrev_b32 v136, 16, v116
    v_and_b32 v137, 0xffff0000, v116
    v_lshlrev_b32 v138, 16, v117
    v_and_b32 v139, 0xffff0000, v117
    v_lshlrev_b32 v140, 16, v118
    v_and_b32 v141, 0xffff0000, v118
    v_lshlrev_b32 v142, 16, v119
    v_and_b32 v143, 0xffff0000, v119
    v_lshlrev_b32 v144, 16, v120
    v_and_b32 v145, 0xffff0000, v120
    v_lshlrev_b32_e64 v146, 16, v121
    v_and_b32 v147, 0xffff0000, v121
    v_pk_add_f32 v[2:3], v[128:129], v[130:131]
    v_pk_mul_f32 v[6:7], v[128:129], v[128:129]
    v_pk_fma_f32 v[6:7], v[130:131], v[130:131], v[6:7]
    v_pk_add_f32 v[2:3], v[2:3], v[132:133]
    v_pk_fma_f32 v[6:7], v[132:133], v[132:133], v[6:7]
    v_pk_add_f32 v[2:3], v[2:3], v[134:135]
    v_pk_fma_f32 v[6:7], v[134:135], v[134:135], v[6:7]
    v_pk_add_f32 v[2:3], v[2:3], v[136:137]
    v_pk_fma_f32 v[6:7], v[136:137], v[136:137], v[6:7]
    v_pk_add_f32 v[2:3], v[2:3], v[138:139]
    v_pk_fma_f32 v[6:7], v[138:139], v[138:139], v[6:7]
    v_pk_add_f32 v[2:3], v[2:3], v[140:141]
    v_pk_fma_f32 v[6:7], v[140:141], v[140:141], v[6:7]
    v_pk_add_f32 v[2:3], v[2:3], v[142:143]
    v_pk_fma_f32 v[6:7], v[142:143], v[142:143], v[6:7]
    v_pk_add_f32 v[2:3], v[2:3], v[144:145]
    v_pk_fma_f32 v[6:7], v[144:145], v[144:145], v[6:7]
    v_pk_add_f32 v[2:3], v[2:3], v[146:147]
    v_pk_fma_f32 v[6:7], v[146:147], v[146:147], v[6:7]
    v_add_f32 v2, v2, v3
    v_add_f32 v3, v6, v7
    v_mov_b32 v4, v2
    v_mov_b32 v5, v3
    s_nop 0
    v_permlane16_swap_b32 v2, v4
    v_permlane16_swap_b32 v3, v5
    v_pk_add_f32 v[2:3], v[2:3], v[4:5]
    v_mov_b32 v4, v2
    v_mov_b32 v5, v3
    s_nop 0
    v_permlane32_swap_b32 v2, v4
    v_permlane32_swap_b32 v3, v5
    v_pk_add_f32 v[2:3], v[2:3], v[4:5]
    v_mul_f32 v4, 0xbc4ccccd, v2
    v_fmac_f32 v3, v4, v2
    v_max_f32 v3, 0, v3
    v_lshlrev_b32 v4, 3, v1
    s_mov_b64 exec, 0xffff
    buffer_store_dwordx2 v[2:3], v4, s[12:15], s83 offen sc1
    s_mov_b64 exec, -1
    v_accvgpr_read_b32 v13, a251
    v_add_u32 v14, 57344, v13
    v_add_u32 v17, 114688, v13
    v_and_b32 v8, 31, v1
    v_lshlrev_b32 v8, 3, v8
    s_add_u32 m0, s90, 86240
    s_nop 0
    buffer_load_dwordx4 v10, s[32:35], s89 offen offset:0 lds
    buffer_load_dwordx4 v11, s[32:35], s89 offen offset:1024 lds
    buffer_load_dwordx4 v12, s[32:35], s89 offen offset:2048 lds
    s_add_u32 s89, s89, 98304
    s_waitcnt vmcnt(3) lgkmcnt(0)
    s_barrier
    s_add_u32 s73, s73, 2048
    s_cmp_lg_u32 s3, 0
    s_cbranch_scc1 Lw0_28
    v_mov_b32 v30, s54
    v_mov_b32 v31, s55
    s_mov_b64 exec, 1
    s_cmp_eq_u32 s98, 1
    s_cbranch_scc1 Lf_29
    buffer_store_dwordx2 v[30:31], off, s[12:15], s73 sc1
    s_branch Lg_30
Lf_29:
    buffer_store_dwordx2 v[30:31], off, s[12:15], s73
Lg_30:
    s_mov_b64 exec, -1
Lw0_28:
    s_add_u32 m0, s90, 98560
    s_nop 0
    buffer_load_dwordx4 v10, s[32:35], s89 offen offset:0 lds
    buffer_load_dwordx4 v11, s[32:35], s89 offen offset:1024 lds
    buffer_load_dwordx4 v12, s[32:35], s89 offen offset:2048 lds
    s_add_u32 s89, s89, 98304
    ds_read_b64_tr_b16 v[48:49], v13 offset:49280
    ds_read_b64_tr_b16 v[50:51], v13 offset:50048
    ds_read_b64_tr_b16 v[52:53], v13 offset:49312
    ds_read_b64_tr_b16 v[54:55], v13 offset:50080
    ds_read_b64_tr_b16 v[56:57], v13 offset:49344
    ds_read_b64_tr_b16 v[58:59], v13 offset:50112
    ds_read_b64_tr_b16 v[60:61], v13 offset:49376
    ds_read_b64_tr_b16 v[62:63], v13 offset:50144
    ds_read_b64_tr_b16 v[64:65], v13 offset:49408
    ds_read_b64_tr_b16 v[66:67], v13 offset:50176
    s_add_u32 s52, s97, 2048
    s_mov_b32 s53, 200000
Lp_31:
    buffer_load_dwordx2 v[2:3], v18, s[12:15], s52 offen sc1
    s_waitcnt vmcnt(0)
    v_cmp_ne_u64 vcc, s[54:55], v[2:3]
    s_cbranch_vccz Ld_32
    s_sleep 1
    s_sub_u32 s53, s53, 1
    s_cmp_gt_i32 s53, 0
    s_cbranch_scc1 Lp_31
Ld_32:
    s_waitcnt vmcnt(0)
    buffer_load_dwordx4 v[20:23], v16, s[12:15], s85 offen offset:0 sc1
    buffer_load_dwordx4 v[24:27], v16, s[12:15], s85 offen offset:1024 sc1
    buffer_load_dwordx4 v[28:31], v16, s[12:15], s85 offen offset:2048 sc1
    buffer_load_dwordx4 v[32:35], v16, s[12:15], s85 offen offset:3072 sc1
    s_add_u32 s85, s85, 4096
    buffer_load_dwordx4 v[36:39], v16, s[12:15], s85 offen offset:0 sc1
    buffer_load_dwordx4 v[40:43], v16, s[12:15], s85 offen offset:1024 sc1
    buffer_load_dwordx4 v[44:47], v16, s[12:15], s85 offen offset:2048 sc1
    buffer_load_dwordx4 v[224:227], v16, s[12:15], s85 offen offset:3072 sc1
    s_add_u32 s85, s85, 4096
    s_waitcnt lgkmcnt(4) vmcnt(7)
    v_mfma_f32_32x32x16_bf16 v[128:143], v[48:51], v[20:23], 0
    ds_read_b64_tr_b16 v[68:69], v13 offset:49440
    ds_read_b64_tr_b16 v[70:71], v13 offset:50208
    v_mfma_f32_32x32x16_bf16 v[144:159], v[52:55], v[20:23], 0
    ds_read_b64_tr_b16 v[72:73], v13 offset:52352
    ds_read_b64_tr_b16 v[74:75], v13 offset:53120
    buffer_load_dwordx4 v[228:231], v16, s[12:15], s85 offen offset:0 sc1
    v_mfma_f32_32x32x16_bf16 v[160:175], v[56:59], v[20:23], 0
    ds_read_b64_tr_b16 v[76:77], v13 offset:52384
    ds_read_b64_tr_b16 v[78:79], v13 offset:53152
    s_add_u32 m0, s90, 110880
    s_nop 0
    buffer_load_dwordx4 v10, s[32:35], s89 offen offset:0 lds
    s_waitcnt lgkmcnt(4)
    v_mfma_f32_32x32x16_bf16 v[176:191], v[60:63], v[20:23], 0
    ds_read_b64_tr_b16 v[80:81], v13 offset:52416
    ds_read_b64_tr_b16 v[82:83], v13 offset:53184
    v_mfma_f32_32x32x16_bf16 v[192:207], v[64:67], v[20:23], 0
    ds_read_b64_tr_b16 v[84:85], v13 offset:52448
    ds_read_b64_tr_b16 v[86:87], v13 offset:53216
    v_mfma_f32_32x32x16_bf16 v[208:223], v[68:71], v[20:23], 0
    ds_read_b64_tr_b16 v[88:89], v13 offset:52480
    ds_read_b64_tr_b16 v[90:91], v13 offset:53248
    s_waitcnt lgkmcnt(4) vmcnt(8)
    v_mfma_f32_32x32x16_bf16 v[128:143], v[72:75], v[24:27], v[128:143]
    ds_read_b64_tr_b16 v[92:93], v13 offset:52512
    ds_read_b64_tr_b16 v[94:95], v13 offset:53280
    buffer_load_dwordx4 v11, s[32:35], s89 offen offset:1024 lds
    s_barrier
    v_mfma_f32_32x32x16_bf16 v[144:159], v[76:79], v[24:27], v[144:159]
    ds_read_b64_tr_b16 v[48:49], v14 offset:4256
    ds_read_b64_tr_b16 v[50:51], v14 offset:5024
    buffer_load_dwordx4 v[232:235], v16, s[12:15], s85 offen offset:1024 sc1
    v_mfma_f32_32x32x16_bf16 v[160:175], v[80:83], v[24:27], v[160:175]
    ds_read_b64_tr_b16 v[52:53], v14 offset:4288
    ds_read_b64_tr_b16 v[54:55], v14 offset:5056
    s_cmp_lg_u32 s3, 0
    s_cbranch_scc1 Lw0_33
    buffer_load_dwordx4 v[2:5], v16, s[12:15], 0 offen offset:2048 sc1
Lw0_33:
    s_waitcnt lgkmcnt(4)
    v_mfma_f32_32x32x16_bf16 v[176:191], v[84:87], v[24:27], v[176:191]
    ds_read_b64_tr_b16 v[56:57], v14 offset:4320
    ds_read_b64_tr_b16 v[58:59], v14 offset:5088
    v_mfma_f32_32x32x16_bf16 v[192:207], v[88:91], v[24:27], v[192:207]
    ds_read_b64_tr_b16 v[60:61], v14 offset:4352
    ds_read_b64_tr_b16 v[62:63], v14 offset:5120
    buffer_load_dwordx4 v12, s[32:35], s89 offen offset:2048 lds
    s_add_u32 s89, s89, 98304
    v_mfma_f32_32x32x16_bf16 v[208:223], v[92:95], v[24:27], v[208:223]
    ds_read_b64_tr_b16 v[64:65], v14 offset:4384
    ds_read_b64_tr_b16 v[66:67], v14 offset:5152
    s_waitcnt lgkmcnt(4) vmcnt(10)
    v_mfma_f32_32x32x16_bf16 v[128:143], v[48:51], v[28:31], v[128:143]
    ds_read_b64_tr_b16 v[68:69], v14 offset:4416
    ds_read_b64_tr_b16 v[70:71], v14 offset:5184
    v_mfma_f32_32x32x16_bf16 v[144:159], v[52:55], v[28:31], v[144:159]
    ds_read_b64_tr_b16 v[72:73], v14 offset:7328
    ds_read_b64_tr_b16 v[74:75], v14 offset:8096
    buffer_load_dwordx4 v[236:239], v16, s[12:15], s85 offen offset:2048 sc1
    v_mfma_f32_32x32x16_bf16 v[160:175], v[56:59], v[28:31], v[160:175]
    ds_read_b64_tr_b16 v[76:77], v14 offset:7360
    ds_read_b64_tr_b16 v[78:79], v14 offset:8128
    s_add_u32 m0, s90, 123200
    s_nop 0
    buffer_load_dwordx4 v10, s[32:35], s89 offen offset:0 lds
    s_waitcnt lgkmcnt(4)
    v_mfma_f32_32x32x16_bf16 v[176:191], v[60:63], v[28:31], v[176:191]
    ds_read_b64_tr_b16 v[80:81], v14 offset:7392
    ds_read_b64_tr_b16 v[82:83], v14 offset:8160
    v_mfma_f32_32x32x16_bf16 v[192:207], v[64:67], v[28:31], v[192:207]
    ds_read_b64_tr_b16 v[84:85], v14 offset:7424
    ds_read_b64_tr_b16 v[86:87], v14 offset:8192
    buffer_load_dwordx2 v[96:97], v8, s[12:15], s86 offen offset:0 sc1
    v_mfma_f32_32x32x16_bf16 v[208:223], v[68:71], v[28:31], v[208:223]
    ds_read_b64_tr_b16 v[88:89], v14 offset:7456
    ds_read_b64_tr_b16 v[90:91], v14 offset:8224
    s_waitcnt lgkmcnt(4) vmcnt(12)
    v_mfma_f32_32x32x16_bf16 v[128:143], v[72:75], v[32:35], v[128:143]
    ds_read_b64_tr_b16 v[92:93], v14 offset:7488
    ds_read_b64_tr_b16 v[94:95], v14 offset:8256
    buffer_load_dwordx4 v11, s[32:35], s89 offen offset:1024 lds
    v_mfma_f32_32x32x16_bf16 v[144:159], v[76:79], v[32:35], v[144:159]
    ds_read_b64_tr_b16 v[48:49], v13 offset:0
    ds_read_b64_tr_b16 v[50:51], v13 offset:768
    buffer_load_dwordx4 v[240:243], v16, s[12:15], s85 offen offset:3072 sc1
    s_add_u32 s85, s85, 4096
    v_mfma_f32_32x32x16_bf16 v[160:175], v[80:83], v[32:35], v[160:175]
    ds_read_b64_tr_b16 v[52:53], v13 offset:32
    ds_read_b64_tr_b16 v[54:55], v13 offset:800
    s_waitcnt lgkmcnt(4)
    v_mfma_f32_32x32x16_bf16 v[176:191], v[84:87], v[32:35], v[176:191]
    ds_read_b64_tr_b16 v[56:57], v13 offset:64
    ds_read_b64_tr_b16 v[58:59], v13 offset:832
    v_mfma_f32_32x32x16_bf16 v[192:207], v[88:91], v[32:35], v[192:207]
    ds_read_b64_tr_b16 v[60:61], v13 offset:96
    ds_read_b64_tr_b16 v[62:63], v13 offset:864
    buffer_load_dwordx4 v12, s[32:35], s89 offen offset:2048 lds
    s_add_u32 s89, s89, 98304
    buffer_load_dwordx2 v[98:99], v8, s[12:15], s86 offen offset:1024 sc1
    v_mfma_f32_32x32x16_bf16 v[208:223], v[92:95], v[32:35], v[208:223]
    ds_read_b64_tr_b16 v[64:65], v13 offset:128
    ds_read_b64_tr_b16 v[66:67], v13 offset:896
    s_waitcnt lgkmcnt(4) vmcnt(15)
    v_mfma_f32_32x32x16_bf16 v[128:143], v[48:51], v[36:39], v[128:143]
    ds_read_b64_tr_b16 v[68:69], v13 offset:160
    ds_read_b64_tr_b16 v[70:71], v13 offset:928
    v_mfma_f32_32x32x16_bf16 v[144:159], v[52:55], v[36:39], v[144:159]
    ds_read_b64_tr_b16 v[72:73], v13 offset:3072
    ds_read_b64_tr_b16 v[74:75], v13 offset:3840
    buffer_load_dwordx4 v[244:247], v16, s[12:15], s85 offen offset:0 sc1
    v_mfma_f32_32x32x16_bf16 v[160:175], v[56:59], v[36:39], v[160:175]
    ds_read_b64_tr_b16 v[76:77], v13 offset:3104
    ds_read_b64_tr_b16 v[78:79], v13 offset:3872
    s_add_u32 m0, s90, 135520
    s_nop 0
    buffer_load_dwordx4 v10, s[32:35], s89 offen offset:0 lds
    s_waitcnt lgkmcnt(4)
    v_mfma_f32_32x32x16_bf16 v[176:191], v[60:63], v[36:39], v[176:191]
    ds_read_b64_tr_b16 v[80:81], v13 offset:3136
    ds_read_b64_tr_b16 v[82:83], v13 offset:3904
    v_mfma_f32_32x32x16_bf16 v[192:207], v[64:67], v[36:39], v[192:207]
    ds_read_b64_tr_b16 v[84:85], v13 offset:3168
    ds_read_b64_tr_b16 v[86:87], v13 offset:3936
    buffer_load_dwordx2 v[100:101], v8, s[12:15], s86 offen offset:2048 sc1
    v_mfma_f32_32x32x16_bf16 v[208:223], v[68:71], v[36:39], v[208:223]
    ds_read_b64_tr_b16 v[88:89], v13 offset:3200
    ds_read_b64_tr_b16 v[90:91], v13 offset:3968
    s_waitcnt lgkmcnt(4) vmcnt(17)
    v_mfma_f32_32x32x16_bf16 v[128:143], v[72:75], v[40:43], v[128:143]
    ds_read_b64_tr_b16 v[92:93], v13 offset:3232
    ds_read_b64_tr_b16 v[94:95], v13 offset:4000
    buffer_load_dwordx4 v11, s[32:35], s89 offen offset:1024 lds
    s_barrier
    v_mfma_f32_32x32x16_bf16 v[144:159], v[76:79], v[40:43], v[144:159]
    ds_read_b64_tr_b16 v[48:49], v13 offset:12320
    ds_read_b64_tr_b16 v[50:51], v13 offset:13088
    buffer_load_dwordx4 v[248:251], v16, s[12:15], s85 offen offset:1024 sc1
    v_mfma_f32_32x32x16_bf16 v[160:175], v[80:83], v[40:43], v[160:175]
    ds_read_b64_tr_b16 v[52:53], v13 offset:12352
    ds_read_b64_tr_b16 v[54:55], v13 offset:13120
    s_waitcnt lgkmcnt(4)
    v_mfma_f32_32x32x16_bf16 v[176:191], v[84:87], v[40:43], v[176:191]
    ds_read_b64_tr_b16 v[56:57], v13 offset:12384
    ds_read_b64_tr_b16 v[58:59], v13 offset:13152
    v_mfma_f32_32x32x16_bf16 v[192:207], v[88:91], v[40:43], v[192:207]
    ds_read_b64_tr_b16 v[60:61], v13 offset:12416
    ds_read_b64_tr_b16 v[62:63], v13 offset:13184
    buffer_load_dwordx4 v12, s[32:35], s89 offen offset:2048 lds
    s_add_u32 s89, s89, 98304
    buffer_load_dwordx2 v[102:103], v8, s[12:15], s86 offen offset:3072 sc1
    v_mfma_f32_32x32x16_bf16 v[208:223], v[92:95], v[40:43], v[208:223]
    ds_read_b64_tr_b16 v[64:65], v13 offset:12448
    ds_read_b64_tr_b16 v[66:67], v13 offset:13216
    s_waitcnt lgkmcnt(4) vmcnt(20)
    v_mfma_f32_32x32x16_bf16 v[128:143], v[48:51], v[44:47], v[128:143]
    ds_read_b64_tr_b16 v[68:69], v13 offset:12480
    ds_read_b64_tr_b16 v[70:71], v13 offset:13248
    v_mfma_f32_32x32x16_bf16 v[144:159], v[52:55], v[44:47], v[144:159]
    ds_read_b64_tr_b16 v[72:73], v13 offset:15392
    ds_read_b64_tr_b16 v[74:75], v13 offset:16160
    buffer_load_dwordx4 v[252:255], v16, s[12:15], s85 offen offset:2048 sc1
    v_mfma_f32_32x32x16_bf16 v[160:175], v[56:59], v[44:47], v[160:175]
    ds_read_b64_tr_b16 v[76:77], v13 offset:15424
    ds_read_b64_tr_b16 v[78:79], v13 offset:16192
    s_waitcnt lgkmcnt(4)
    v_mfma_f32_32x32x16_bf16 v[176:191], v[60:63], v[44:47], v[176:191]
    ds_read_b64_tr_b16 v[80:81], v13 offset:15456
    ds_read_b64_tr_b16 v[82:83], v13 offset:16224
    v_mfma_f32_32x32x16_bf16 v[192:207], v[64:67], v[44:47], v[192:207]
    ds_read_b64_tr_b16 v[84:85], v13 offset:15488
    ds_read_b64_tr_b16 v[86:87], v13 offset:16256
    s_add_u32 s51, s86, 4096
    v_mfma_f32_32x32x16_bf16 v[208:223], v[68:71], v[44:47], v[208:223]
    ds_read_b64_tr_b16 v[88:89], v13 offset:15520
    ds_read_b64_tr_b16 v[90:91], v13 offset:16288
    s_waitcnt lgkmcnt(4) vmcnt(20)
    v_mfma_f32_32x32x16_bf16 v[128:143], v[72:75], v[224:227], v[128:143]
    ds_read_b64_tr_b16 v[92:93], v13 offset:15552
    ds_read_b64_tr_b16 v[94:95], v13 offset:16320
    v_mfma_f32_32x32x16_bf16 v[144:159], v[76:79], v[224:227], v[144:159]
    ds_read_b64_tr_b16 v[48:49], v13 offset:24640
    ds_read_b64_tr_b16 v[50:51], v13 offset:25408
    buffer_load_dwordx4 v[20:23], v16, s[12:15], s85 offen offset:3072 sc1
    s_add_u32 s85, s85, 4096
    v_mfma_f32_32x32x16_bf16 v[160:175], v[80:83], v[224:227], v[160:175]
    ds_read_b64_tr_b16 v[52:53], v13 offset:24672
    ds_read_b64_tr_b16 v[54:55], v13 offset:25440
    s_waitcnt lgkmcnt(4)
    v_mfma_f32_32x32x16_bf16 v[176:191], v[84:87], v[224:227], v[176:191]
    ds_read_b64_tr_b16 v[56:57], v13 offset:24704
    ds_read_b64_tr_b16 v[58:59], v13 offset:25472
    v_mfma_f32_32x32x16_bf16 v[192:207], v[88:91], v[224:227], v[192:207]
    ds_read_b64_tr_b16 v[60:61], v13 offset:24736
    ds_read_b64_tr_b16 v[62:63], v13 offset:25504
    buffer_load_dwordx2 v[104:105], v8, s[12:15], s51 offen offset:0 sc1
    v_mfma_f32_32x32x16_bf16 v[208:223], v[92:95], v[224:227], v[208:223]
    ds_read_b64_tr_b16 v[64:65], v13 offset:24768
    ds_read_b64_tr_b16 v[66:67], v13 offset:25536
    s_waitcnt lgkmcnt(4) vmcnt(21)
    v_mfma_f32_32x32x16_bf16 v[128:143], v[48:51], v[228:231], v[128:143]
    ds_read_b64_tr_b16 v[68:69], v13 offset:24800
    ds_read_b64_tr_b16 v[70:71], v13 offset:25568
    s_add_u32 m0, s90, 49280
    s_nop 0
    buffer_load_dwordx4 v10, s[32:35], s89 offen offset:0 lds
    v_mfma_f32_32x32x16_bf16 v[144:159], v[52:55], v[228:231], v[144:159]
    ds_read_b64_tr_b16 v[72:73], v13 offset:27712
    ds_read_b64_tr_b16 v[74:75], v13 offset:28480
    buffer_load_dwordx4 v[24:27], v16, s[12:15], s85 offen offset:0 sc1
    v_mfma_f32_32x32x16_bf16 v[160:175], v[56:59], v[228:231], v[160:175]
    ds_read_b64_tr_b16 v[76:77], v13 offset:27744
    ds_read_b64_tr_b16 v[78:79], v13 offset:28512
    s_waitcnt lgkmcnt(4)
    v_mfma_f32_32x32x16_bf16 v[176:191], v[60:63], v[228:231], v[176:191]
    ds_read_b64_tr_b16 v[80:81], v13 offset:27776
    ds_read_b64_tr_b16 v[82:83], v13 offset:28544
    v_mfma_f32_32x32x16_bf16 v[192:207], v[64:67], v[228:231], v[192:207]
    ds_read_b64_tr_b16 v[84:85], v13 offset:27808
    ds_read_b64_tr_b16 v[86:87], v13 offset:28576
    buffer_load_dwordx4 v11, s[32:35], s89 offen offset:1024 lds
    buffer_load_dwordx2 v[106:107], v8, s[12:15], s51 offen offset:1024 sc1
    v_mfma_f32_32x32x16_bf16 v[208:223], v[68:71], v[228:231], v[208:223]
    ds_read_b64_tr_b16 v[88:89], v13 offset:27840
    ds_read_b64_tr_b16 v[90:91], v13 offset:28608
    s_waitcnt lgkmcnt(4) vmcnt(22)
    v_mfma_f32_32x32x16_bf16 v[128:143], v[72:75], v[232:235], v[128:143]
    ds_read_b64_tr_b16 v[92:93], v13 offset:27872
    ds_read_b64_tr_b16 v[94:95], v13 offset:28640
    s_barrier
    v_mfma_f32_32x32x16_bf16 v[144:159], v[76:79], v[232:235], v[144:159]
    ds_read_b64_tr_b16 v[48:49], v13 offset:36960
    ds_read_b64_tr_b16 v[50:51], v13 offset:37728
    buffer_load_dwordx4 v[28:31], v16, s[12:15], s85 offen offset:1024 sc1
    v_mfma_f32_32x32x16_bf16 v[160:175], v[80:83], v[232:235], v[160:175]
    ds_read_b64_tr_b16 v[52:53], v13 offset:36992
    ds_read_b64_tr_b16 v[54:55], v13 offset:37760
    buffer_load_dwordx4 v12, s[32:35], s89 offen offset:2048 lds
    s_add_u32 s89, s89, 98304
    s_waitcnt vmcnt(15)
    s_cmp_lg_u32 s3, 0
    s_cbranch_scc1 Lw0_37
    v_cmp_ne_u32 vcc, s54, v2
    v_cmp_ne_u32 s[66:67], s54, v3
    s_nop 0
    s_or_b64 vcc, vcc, s[66:67]
    v_cmp_ne_u32 s[66:67], s54, v4
    s_nop 0
    s_or_b64 vcc, vcc, s[66:67]
    v_cmp_ne_u32 s[66:67], s54, v5
    s_nop 0
    s_or_b64 vcc, vcc, s[66:67]
    s_cbranch_vccnz Ls_34
Lb_35:
Lw0_37:
    v_lshlrev_b32 v126, 2, v0
    v_cmp_gt_u32 vcc, 192, v0
    v_mov_b32 v3, 1073741824
    s_nop 0
    v_cndmask_b32 v9, v3, v126, vcc
    s_waitcnt lgkmcnt(4)
    v_mfma_f32_32x32x16_bf16 v[176:191], v[84:87], v[232:235], v[176:191]
    ds_read_b64_tr_b16 v[56:57], v13 offset:37024
    ds_read_b64_tr_b16 v[58:59], v13 offset:37792
    v_mfma_f32_32x32x16_bf16 v[192:207], v[88:91], v[232:235], v[192:207]
    ds_read_b64_tr_b16 v[60:61], v13 offset:37056
    ds_read_b64_tr_b16 v[62:63], v13 offset:37824
    buffer_load_dwordx2 v[108:109], v8, s[12:15], s51 offen offset:2048 sc1
    v_mfma_f32_32x32x16_bf16 v[208:223], v[92:95], v[232:235], v[208:223]
    ds_read_b64_tr_b16 v[64:65], v13 offset:37088
    ds_read_b64_tr_b16 v[66:67], v13 offset:37856
    s_waitcnt lgkmcnt(4)
    v_mfma_f32_32x32x16_bf16 v[128:143], v[48:51], v[236:239], v[128:143]
    ds_read_b64_tr_b16 v[68:69], v13 offset:37120
    ds_read_b64_tr_b16 v[70:71], v13 offset:37888
    s_add_u32 m0, s90, 61600
    s_nop 0
    buffer_load_dwordx4 v10, s[32:35], s89 offen offset:0 lds
    v_mfma_f32_32x32x16_bf16 v[144:159], v[52:55], v[236:239], v[144:159]
    ds_read_b64_tr_b16 v[72:73], v13 offset:40032
    ds_read_b64_tr_b16 v[74:75], v13 offset:40800
    buffer_load_dwordx4 v[32:35], v16, s[12:15], s85 offen offset:2048 sc1
    v_mfma_f32_32x32x16_bf16 v[160:175], v[56:59], v[236:239], v[160:175]
    ds_read_b64_tr_b16 v[76:77], v13 offset:40064
    ds_read_b64_tr_b16 v[78:79], v13 offset:40832
    s_waitcnt lgkmcnt(4)
    v_mfma_f32_32x32x16_bf16 v[176:191], v[60:63], v[236:239], v[176:191]
    ds_read_b64_tr_b16 v[80:81], v13 offset:40096
    ds_read_b64_tr_b16 v[82:83], v13 offset:40864
    v_mfma_f32_32x32x16_bf16 v[192:207], v[64:67], v[236:239], v[192:207]
    ds_read_b64_tr_b16 v[84:85], v13 offset:40128
    ds_read_b64_tr_b16 v[86:87], v13 offset:40896
    buffer_load_dwordx4 v11, s[32:35], s89 offen offset:1024 lds
    buffer_load_dwordx2 v[110:111], v8, s[12:15], s51 offen offset:3072 sc1
    v_mfma_f32_32x32x16_bf16 v[208:223], v[68:71], v[236:239], v[208:223]
    ds_read_b64_tr_b16 v[88:89], v13 offset:40160
    ds_read_b64_tr_b16 v[90:91], v13 offset:40928
    s_waitcnt lgkmcnt(4)
    v_mfma_f32_32x32x16_bf16 v[128:143], v[72:75], v[240:243], v[128:143]
    ds_read_b64_tr_b16 v[92:93], v13 offset:40192
    ds_read_b64_tr_b16 v[94:95], v13 offset:40960
    v_mfma_f32_32x32x16_bf16 v[144:159], v[76:79], v[240:243], v[144:159]
    ds_read_b64_tr_b16 v[48:49], v14 offset:16576
    ds_read_b64_tr_b16 v[50:51], v14 offset:17344
    buffer_load_dwordx4 v[36:39], v16, s[12:15], s85 offen offset:3072 sc1
    s_add_u32 s85, s85, 4096
    v_mfma_f32_32x32x16_bf16 v[160:175], v[80:83], v[240:243], v[160:175]
    ds_read_b64_tr_b16 v[52:53], v14 offset:16608
    ds_read_b64_tr_b16 v[54:55], v14 offset:17376
    buffer_load_dwordx4 v12, s[32:35], s89 offen offset:2048 lds
    s_add_u32 s89, s89, 98304
    s_waitcnt lgkmcnt(4)
    v_mfma_f32_32x32x16_bf16 v[176:191], v[84:87], v[240:243], v[176:191]
    ds_read_b64_tr_b16 v[56:57], v14 offset:16640
    ds_read_b64_tr_b16 v[58:59], v14 offset:17408
    v_mfma_f32_32x32x16_bf16 v[192:207], v[88:91], v[240:243], v[192:207]
    ds_read_b64_tr_b16 v[60:61], v14 offset:16672
    ds_read_b64_tr_b16 v[62:63], v14 offset:17440
    v_mfma_f32_32x32x16_bf16 v[208:223], v[92:95], v[240:243], v[208:223]
    ds_read_b64_tr_b16 v[64:65], v14 offset:16704
    ds_read_b64_tr_b16 v[66:67], v14 offset:17472
    s_waitcnt lgkmcnt(4)
    v_mfma_f32_32x32x16_bf16 v[128:143], v[48:51], v[244:247], v[128:143]
    ds_read_b64_tr_b16 v[68:69], v14 offset:16736
    ds_read_b64_tr_b16 v[70:71], v14 offset:17504
    s_add_u32 m0, s90, 0
    s_nop 0
    buffer_load_dwordx4 v10, s[32:35], s89 offen offset:0 lds
    v_mfma_f32_32x32x16_bf16 v[144:159], v[52:55], v[244:247], v[144:159]
    ds_read_b64_tr_b16 v[72:73], v14 offset:19648
    ds_read_b64_tr_b16 v[74:75], v14 offset:20416
    buffer_load_dwordx4 v[40:43], v16, s[12:15], s85 offen offset:0 sc1
    v_mfma_f32_32x32x16_bf16 v[160:175], v[56:59], v[244:247], v[160:175]
    ds_read_b64_tr_b16 v[76:77], v14 offset:19680
    ds_read_b64_tr_b16 v[78:79], v14 offset:20448
    s_waitcnt lgkmcnt(4)
    v_mfma_f32_32x32x16_bf16 v[176:191], v[60:63], v[244:247], v[176:191]
    ds_read_b64_tr_b16 v[80:81], v14 offset:19712
    ds_read_b64_tr_b16 v[82:83], v14 offset:20480
    v_mfma_f32_32x32x16_bf16 v[192:207], v[64:67], v[244:247], v[192:207]
    ds_read_b64_tr_b16 v[84:85], v14 offset:19744
    ds_read_b64_tr_b16 v[86:87], v14 offset:20512
    buffer_load_dwordx4 v11, s[32:35], s89 offen offset:1024 lds
    v_mfma_f32_32x32x16_bf16 v[208:223], v[68:71], v[244:247], v[208:223]
    ds_read_b64_tr_b16 v[88:89], v14 offset:19776
    ds_read_b64_tr_b16 v[90:91], v14 offset:20544
    s_waitcnt lgkmcnt(4) vmcnt(21)
    v_mfma_f32_32x32x16_bf16 v[128:143], v[72:75], v[248:251], v[128:143]
    ds_read_b64_tr_b16 v[92:93], v14 offset:19808
    ds_read_b64_tr_b16 v[94:95], v14 offset:20576
    s_barrier
    v_mfma_f32_32x32x16_bf16 v[144:159], v[76:79], v[248:251], v[144:159]
    ds_read_b64_tr_b16 v[48:49], v14 offset:28896
    ds_read_b64_tr_b16 v[50:51], v14 offset:29664
    buffer_load_dwordx4 v[44:47], v16, s[12:15], s85 offen offset:1024 sc1
    v_mfma_f32_32x32x16_bf16 v[160:175], v[80:83], v[248:251], v[160:175]
    ds_read_b64_tr_b16 v[52:53], v14 offset:28928
    ds_read_b64_tr_b16 v[54:55], v14 offset:29696
    buffer_load_dwordx4 v12, s[32:35], s89 offen offset:2048 lds
    s_add_u32 s89, s89, 98304
    s_waitcnt lgkmcnt(4)
    v_mfma_f32_32x32x16_bf16 v[176:191], v[84:87], v[248:251], v[176:191]
    ds_read_b64_tr_b16 v[56:57], v14 offset:28960
    ds_read_b64_tr_b16 v[58:59], v14 offset:29728
    v_mfma_f32_32x32x16_bf16 v[192:207], v[88:91], v[248:251], v[192:207]
    ds_read_b64_tr_b16 v[60:61], v14 offset:28992
    ds_read_b64_tr_b16 v[62:63], v14 offset:29760
    v_mfma_f32_32x32x16_bf16 v[208:223], v[92:95], v[248:251], v[208:223]
    ds_read_b64_tr_b16 v[64:65], v14 offset:29024
    ds_read_b64_tr_b16 v[66:67], v14 offset:29792
    s_waitcnt lgkmcnt(4) vmcnt(20)
    v_mfma_f32_32x32x16_bf16 v[128:143], v[48:51], v[252:255], v[128:143]
    ds_read_b64_tr_b16 v[68:69], v14 offset:29056
    ds_read_b64_tr_b16 v[70:71], v14 offset:29824
    s_add_u32 m0, s90, 12320
    s_nop 0
    buffer_load_dwordx4 v10, s[32:35], s89 offen offset:0 lds
    s_waitcnt vmcnt(8)
    v_add_f32 v2, v96, v98
    v_mfma_f32_32x32x16_bf16 v[144:159], v[52:55], v[252:255], v[144:159]
    ds_read_b64_tr_b16 v[72:73], v14 offset:31968
    ds_read_b64_tr_b16 v[74:75], v14 offset:32736
    buffer_load_dwordx4 v[224:227], v16, s[12:15], s85 offen offset:2048 sc1
    v_add_f32 v2, v2, v100
    v_add_f32 v2, v2, v102
    v_mfma_f32_32x32x16_bf16 v[160:175], v[56:59], v[252:255], v[160:175]
    ds_read_b64_tr_b16 v[76:77], v14 offset:32000
    ds_read_b64_tr_b16 v[78:79], v14 offset:32768
    v_add_f32 v2, v2, v104
    v_add_f32 v2, v2, v106
    s_waitcnt lgkmcnt(4)
    v_mfma_f32_32x32x16_bf16 v[176:191], v[60:63], v[252:255], v[176:191]
    ds_read_b64_tr_b16 v[80:81], v14 offset:32032
    ds_read_b64_tr_b16 v[82:83], v14 offset:32800
    v_add_f32 v2, v2, v108
    v_add_f32_e64 v2, v2, v110
    v_mfma_f32_32x32x16_bf16 v[192:207], v[64:67], v[252:255], v[192:207]
    ds_read_b64_tr_b16 v[84:85], v14 offset:32064
    ds_read_b64_tr_b16 v[86:87], v14 offset:32832
    buffer_load_dwordx4 v11, s[32:35], s89 offen offset:1024 lds
    v_mul_f32 v122, 0xbacccccd, v2
    v_mfma_f32_32x32x16_bf16 v[208:223], v[68:71], v[252:255], v[208:223]
    ds_read_b64_tr_b16 v[88:89], v14 offset:32096
    ds_read_b64_tr_b16 v[90:91], v14 offset:32864
    v_add_f32 v3, v97, v99
    v_add_f32 v3, v3, v101
    s_waitcnt lgkmcnt(4)
    v_mfma_f32_32x32x16_bf16 v[128:143], v[72:75], v[20:23], v[128:143]
    ds_read_b64_tr_b16 v[92:93], v14 offset:32128
    ds_read_b64_tr_b16 v[94:95], v14 offset:32896
    v_add_f32 v3, v3, v103
    v_add_f32_e64 v3, v3, v105
    v_mfma_f32_32x32x16_bf16 v[144:159], v[76:79], v[20:23], v[144:159]
    ds_read_b64_tr_b16 v[48:49], v14 offset:41216
    ds_read_b64_tr_b16 v[50:51], v14 offset:41984
    buffer_load_dwordx4 v[228:231], v16, s[12:15], s85 offen offset:3072 sc1
    s_add_u32 s85, s85, 4096
    v_add_f32 v3, v3, v107
    v_add_f32 v3, v3, v109
    v_mfma_f32_32x32x16_bf16 v[160:175], v[80:83], v[20:23], v[160:175]
    ds_read_b64_tr_b16 v[52:53], v14 offset:41248
    ds_read_b64_tr_b16 v[54:55], v14 offset:42016
    buffer_load_dwordx4 v12, s[32:35], s89 offen offset:2048 lds
    s_add_u32 s89, s89, 98304
    v_add_f32 v3, v3, v111
    v_mov_b32 v4, 0
    s_waitcnt lgkmcnt(4)
    v_mfma_f32_32x32x16_bf16 v[176:191], v[84:87], v[20:23], v[176:191]
    ds_read_b64_tr_b16 v[56:57], v14 offset:41280
    ds_read_b64_tr_b16 v[58:59], v14 offset:42048
    v_mov_b32 v5, 0x3c4ccccd
    v_mfma_f32_32x32x16_bf16 v[192:207], v[88:91], v[20:23], v[192:207]
    ds_read_b64_tr_b16 v[60:61], v14 offset:41312
    ds_read_b64_tr_b16 v[62:63], v14 offset:42080
    v_fma_f32 v2, v96, v5, v122
    v_fmac_f32 v4, v2, v2
    v_mfma_f32_32x32x16_bf16 v[208:223], v[92:95], v[20:23], v[208:223]
    ds_read_b64_tr_b16 v[64:65], v14 offset:41344
    ds_read_b64_tr_b16 v[66:67], v14 offset:42112
    v_fma_f32 v2, v98, v5, v122
    v_fmac_f32 v4, v2, v2
    s_waitcnt lgkmcnt(4)
    v_mfma_f32_32x32x16_bf16 v[128:143], v[48:51], v[24:27], v[128:143]
    ds_read_b64_tr_b16 v[68:69], v14 offset:41376
    ds_read_b64_tr_b16 v[70:71], v14 offset:42144
    s_add_u32 m0, s90, 24640
    s_nop 0
    buffer_load_dwordx4 v10, s[32:35], s89 offen offset:0 lds
    v_fma_f32 v2, v100, v5, v122
    v_fmac_f32 v4, v2, v2
    v_mfma_f32_32x32x16_bf16 v[144:159], v[52:55], v[24:27], v[144:159]
    ds_read_b64_tr_b16 v[72:73], v14 offset:44288
    ds_read_b64_tr_b16 v[74:75], v14 offset:45056
    buffer_load_dwordx4 v[232:235], v16, s[12:15], s85 offen offset:0 sc1
    v_fma_f32 v2, v102, v5, v122
    v_fmac_f32_e64 v4, v2, v2
    v_mfma_f32_32x32x16_bf16 v[160:175], v[56:59], v[24:27], v[160:175]
    ds_read_b64_tr_b16 v[76:77], v14 offset:44320
    ds_read_b64_tr_b16 v[78:79], v14 offset:45088
    v_fma_f32 v2, v104, v5, v122
    s_waitcnt lgkmcnt(4)
    v_mfma_f32_32x32x16_bf16 v[176:191], v[60:63], v[24:27], v[176:191]
    ds_read_b64_tr_b16 v[80:81], v14 offset:44352
    ds_read_b64_tr_b16 v[82:83], v14 offset:45120
    v_fmac_f32 v4, v2, v2
    v_fma_f32 v2, v106, v5, v122
    v_mfma_f32_32x32x16_bf16 v[192:207], v[64:67], v[24:27], v[192:207]
    ds_read_b64_tr_b16 v[84:85], v14 offset:44384
    ds_read_b64_tr_b16 v[86:87], v14 offset:45152
    buffer_load_dwordx4 v11, s[32:35], s89 offen offset:1024 lds
    v_fmac_f32_e64 v4, v2, v2
    v_fma_f32 v2, v108, v5, v122
    v_mfma_f32_32x32x16_bf16 v[208:223], v[68:71], v[24:27], v[208:223]
    ds_read_b64_tr_b16 v[88:89], v14 offset:44416
    ds_read_b64_tr_b16 v[90:91], v14 offset:45184
    v_fmac_f32 v4, v2, v2
    v_fma_f32 v2, v110, v5, v122
    s_waitcnt lgkmcnt(4)
    v_mfma_f32_32x32x16_bf16 v[128:143], v[72:75], v[28:31], v[128:143]
    ds_read_b64_tr_b16 v[92:93], v14 offset:44448
    ds_read_b64_tr_b16 v[94:95], v14 offset:45216
    v_fmac_f32 v4, v2, v2
    v_mov_b32 v5, 0x42a00000
    s_barrier
    v_mfma_f32_32x32x16_bf16 v[144:159], v[76:79], v[28:31], v[144:159]
    ds_read_b64_tr_b16 v[48:49], v14 offset:53536
    ds_read_b64_tr_b16 v[50:51], v14 offset:54304
    buffer_load_dwordx4 v[236:239], v16, s[12:15], s85 offen offset:1024 sc1
    v_fmac_f32_e64 v3, v4, v5
    v_mfma_f32_32x32x16_bf16 v[160:175], v[80:83], v[28:31], v[160:175]
    ds_read_b64_tr_b16 v[52:53], v14 offset:53568
    ds_read_b64_tr_b16 v[54:55], v14 offset:54336
    buffer_load_dwordx4 v12, s[32:35], s89 offen offset:2048 lds
    s_add_u32 s89, s89, 98304
    v_mov_b32 v124, 0x3727c5ac
    v_fmac_f32 v124, 0x3acccccd, v3
    s_waitcnt lgkmcnt(4)
    v_mfma_f32_32x32x16_bf16 v[176:191], v[84:87], v[28:31], v[176:191]
    ds_read_b64_tr_b16 v[56:57], v14 offset:53600
    ds_read_b64_tr_b16 v[58:59], v14 offset:54368
    v_rsq_f32 v2, v124
    s_nop 0
    v_mul_f32 v6, 0xc0135761, v2
    v_mfma_f32_32x32x16_bf16 v[192:207], v[88:91], v[28:31], v[192:207]
    ds_read_b64_tr_b16 v[60:61], v14 offset:53632
    ds_read_b64_tr_b16 v[62:63], v14 offset:54400
    v_mul_f32 v3, v2, v2
    v_mul_f32 v3, 0x3d372713, v3
    v_mfma_f32_32x32x16_bf16 v[208:223], v[92:95], v[28:31], v[208:223]
    ds_read_b64_tr_b16 v[64:65], v14 offset:53664
    ds_read_b64_tr_b16 v[66:67], v14 offset:54432
    v_mul_f32 v7, v6, v3
    s_waitcnt lgkmcnt(4)
    v_mfma_f32_32x32x16_bf16 v[128:143], v[48:51], v[32:35], v[128:143]
    ds_read_b64_tr_b16 v[68:69], v14 offset:53696
    ds_read_b64_tr_b16 v[70:71], v14 offset:54464
    s_add_u32 m0, s90, 36960
    s_nop 0
    buffer_load_dwordx4 v10, s[32:35], s89 offen offset:0 lds
    v_mfma_f32_32x32x16_bf16 v[144:159], v[52:55], v[32:35], v[144:159]
    ds_read_b64_tr_b16 v[72:73], v14 offset:56608
    ds_read_b64_tr_b16 v[74:75], v14 offset:57376
    buffer_load_dwordx4 v[240:243], v16, s[12:15], s85 offen offset:2048 sc1
    v_mfma_f32_32x32x16_bf16 v[160:175], v[56:59], v[32:35], v[160:175]
    ds_read_b64_tr_b16 v[76:77], v14 offset:56640
    ds_read_b64_tr_b16 v[78:79], v14 offset:57408
    s_waitcnt lgkmcnt(4)
    v_mfma_f32_32x32x16_bf16 v[176:191], v[60:63], v[32:35], v[176:191]
    ds_read_b64_tr_b16 v[80:81], v14 offset:56672
    ds_read_b64_tr_b16 v[82:83], v14 offset:57440
    v_mfma_f32_32x32x16_bf16 v[192:207], v[64:67], v[32:35], v[192:207]
    ds_read_b64_tr_b16 v[84:85], v14 offset:56704
    ds_read_b64_tr_b16 v[86:87], v14 offset:57472
    buffer_load_dwordx4 v11, s[32:35], s89 offen offset:1024 lds
    v_mfma_f32_32x32x16_bf16 v[208:223], v[68:71], v[32:35], v[208:223]
    ds_read_b64_tr_b16 v[88:89], v14 offset:56736
    ds_read_b64_tr_b16 v[90:91], v14 offset:57504
    s_waitcnt lgkmcnt(4) vmcnt(19)
    v_mfma_f32_32x32x16_bf16 v[128:143], v[72:75], v[36:39], v[128:143]
    ds_read_b64_tr_b16 v[92:93], v14 offset:56768
    ds_read_b64_tr_b16 v[94:95], v14 offset:57536
    v_mfma_f32_32x32x16_bf16 v[144:159], v[76:79], v[36:39], v[144:159]
    ds_read_b64_tr_b16 v[48:49], v17 offset:8512
    ds_read_b64_tr_b16 v[50:51], v17 offset:9280
    buffer_load_dwordx4 v[244:247], v16, s[12:15], s85 offen offset:3072 sc1
    s_add_u32 s85, s85, 4096
    v_mfma_f32_32x32x16_bf16 v[160:175], v[80:83], v[36:39], v[160:175]
    ds_read_b64_tr_b16 v[52:53], v17 offset:8544
    ds_read_b64_tr_b16 v[54:55], v17 offset:9312
    buffer_load_dwordx4 v12, s[32:35], s89 offen offset:2048 lds
    s_add_u32 s89, s89, 98304
    buffer_load_dword v2, v9, s[12:15], s92 offen sc1
    s_add_u32 s92, s92, 12288
    s_waitcnt lgkmcnt(4)
    v_mfma_f32_32x32x16_bf16 v[176:191], v[84:87], v[36:39], v[176:191]
    ds_read_b64_tr_b16 v[56:57], v17 offset:8576
    ds_read_b64_tr_b16 v[58:59], v17 offset:9344
    v_mfma_f32_32x32x16_bf16 v[192:207], v[88:91], v[36:39], v[192:207]
    ds_read_b64_tr_b16 v[60:61], v17 offset:8608
    ds_read_b64_tr_b16 v[62:63], v17 offset:9376
    buffer_load_dword v3, v9, s[12:15], s92 offen sc1
    s_add_u32 s92, s92, 12288
    v_mfma_f32_32x32x16_bf16 v[208:223], v[92:95], v[36:39], v[208:223]
    ds_read_b64_tr_b16 v[64:65], v17 offset:8640
    ds_read_b64_tr_b16 v[66:67], v17 offset:9408
    s_waitcnt lgkmcnt(4) vmcnt(20)
    v_mfma_f32_32x32x16_bf16 v[128:143], v[48:51], v[40:43], v[128:143]
    ds_read_b64_tr_b16 v[68:69], v17 offset:8672
    ds_read_b64_tr_b16 v[70:71], v17 offset:9440
    s_add_u32 m0, s90, 73920
    s_nop 0
    buffer_load_dwordx4 v10, s[32:35], s89 offen offset:0 lds
    buffer_load_dword v4, v9, s[12:15], s92 offen sc1
    s_add_u32 s92, s92, 12288
    buffer_load_dwordx4 a[0:3], v16, s[12:15], s88 offen offset:0 sc1
    v_mfma_f32_32x32x16_bf16 v[144:159], v[52:55], v[40:43], v[144:159]
    ds_read_b64_tr_b16 v[72:73], v17 offset:11584
    ds_read_b64_tr_b16 v[74:75], v17 offset:12352
    buffer_load_dwordx4 v[248:251], v16, s[12:15], s85 offen offset:0 sc1
    v_mfma_f32_32x32x16_bf16 v[160:175], v[56:59], v[40:43], v[160:175]
    ds_read_b64_tr_b16 v[76:77], v17 offset:11616
    ds_read_b64_tr_b16 v[78:79], v17 offset:12384
    buffer_load_dword v5, v9, s[12:15], s92 offen sc1
    s_add_u32 s92, s92, 12288
    s_waitcnt lgkmcnt(4)
    v_mfma_f32_32x32x16_bf16 v[176:191], v[60:63], v[40:43], v[176:191]
    ds_read_b64_tr_b16 v[80:81], v17 offset:11648
    ds_read_b64_tr_b16 v[82:83], v17 offset:12416
    v_mfma_f32_32x32x16_bf16 v[192:207], v[64:67], v[40:43], v[192:207]
    ds_read_b64_tr_b16 v[84:85], v17 offset:11680
    ds_read_b64_tr_b16 v[86:87], v17 offset:12448
    buffer_load_dwordx4 v11, s[32:35], s89 offen offset:1024 lds
    buffer_load_dword v96, v9, s[12:15], s92 offen sc1
    buffer_load_dwordx4 a[4:7], v16, s[12:15], s88 offen offset:1024 sc1
    v_mfma_f32_32x32x16_bf16 v[208:223], v[68:71], v[40:43], v[208:223]
    ds_read_b64_tr_b16 v[88:89], v17 offset:11712
    ds_read_b64_tr_b16 v[90:91], v17 offset:12480
    s_waitcnt lgkmcnt(4) vmcnt(26)
    v_mfma_f32_32x32x16_bf16 v[128:143], v[72:75], v[44:47], v[128:143]
    ds_read_b64_tr_b16 v[92:93], v17 offset:11744
    ds_read_b64_tr_b16 v[94:95], v17 offset:12512
    s_barrier
    v_mfma_f32_32x32x16_bf16 v[144:159], v[76:79], v[44:47], v[144:159]
    ds_read_b64_tr_b16 v[48:49], v17 offset:20832
    ds_read_b64_tr_b16 v[50:51], v17 offset:21600
    buffer_load_dwordx4 v[252:255], v16, s[12:15], s85 offen offset:1024 sc1
    v_mfma_f32_32x32x16_bf16 v[160:175], v[80:83], v[44:47], v[160:175]
    ds_read_b64_tr_b16 v[52:53], v17 offset:20864
    ds_read_b64_tr_b16 v[54:55], v17 offset:21632
    buffer_load_dwordx4 v12, s[32:35], s89 offen offset:2048 lds
    s_add_u32 s89, s89, 98304
    s_waitcnt lgkmcnt(4)
    v_mfma_f32_32x32x16_bf16 v[176:191], v[84:87], v[44:47], v[176:191]
    ds_read_b64_tr_b16 v[56:57], v17 offset:20896
    ds_read_b64_tr_b16 v[58:59], v17 offset:21664
    buffer_load_dwordx4 a[8:11], v16, s[12:15], s88 offen offset:2048 sc1
    v_mfma_f32_32x32x16_bf16 v[192:207], v[88:91], v[44:47], v[192:207]
    ds_read_b64_tr_b16 v[60:61], v17 offset:20928
    ds_read_b64_tr_b16 v[62:63], v17 offset:21696
    v_mfma_f32_32x32x16_bf16 v[208:223], v[92:95], v[44:47], v[208:223]
    ds_read_b64_tr_b16 v[64:65], v17 offset:20960
    ds_read_b64_tr_b16 v[66:67], v17 offset:21728
    s_waitcnt lgkmcnt(4) vmcnt(26)
    v_mfma_f32_32x32x16_bf16 v[128:143], v[48:51], v[224:227], v[128:143]
    ds_read_b64_tr_b16 v[68:69], v17 offset:20992
    ds_read_b64_tr_b16 v[70:71], v17 offset:21760
    s_add_u32 m0, s90, 86240
    s_nop 0
    buffer_load_dwordx4 v10, s[32:35], s89 offen offset:0 lds
    v_mfma_f32_32x32x16_bf16 v[144:159], v[52:55], v[224:227], v[144:159]
    ds_read_b64_tr_b16 v[72:73], v17 offset:23904
    ds_read_b64_tr_b16 v[74:75], v17 offset:24672
    buffer_load_dwordx4 v[20:23], v16, s[12:15], s85 offen offset:2048 sc1
    v_mfma_f32_32x32x16_bf16 v[160:175], v[56:59], v[224:227], v[160:175]
    ds_read_b64_tr_b16 v[76:77], v17 offset:23936
    ds_read_b64_tr_b16 v[78:79], v17 offset:24704
    buffer_load_dwordx4 a[12:15], v16, s[12:15], s88 offen offset:3072 sc1
    s_add_u32 s88, s88, 4096
    s_waitcnt lgkmcnt(4)
    v_mfma_f32_32x32x16_bf16 v[176:191], v[60:63], v[224:227], v[176:191]
    ds_read_b64_tr_b16 v[80:81], v17 offset:23968
    ds_read_b64_tr_b16 v[82:83], v17 offset:24736
    v_mfma_f32_32x32x16_bf16 v[192:207], v[64:67], v[224:227], v[192:207]
    ds_read_b64_tr_b16 v[84:85], v17 offset:24000
    ds_read_b64_tr_b16 v[86:87], v17 offset:24768
    buffer_load_dwordx4 v11, s[32:35], s89 offen offset:1024 lds
    v_mfma_f32_32x32x16_bf16 v[208:223], v[68:71], v[224:227], v[208:223]
    ds_read_b64_tr_b16 v[88:89], v17 offset:24032
    ds_read_b64_tr_b16 v[90:91], v17 offset:24800
    s_waitcnt lgkmcnt(4) vmcnt(28)
    v_mfma_f32_32x32x16_bf16 v[128:143], v[72:75], v[228:231], v[128:143]
    ds_read_b64_tr_b16 v[92:93], v17 offset:24064
    ds_read_b64_tr_b16 v[94:95], v17 offset:24832
    buffer_load_dwordx4 a[16:19], v16, s[12:15], s88 offen offset:0 sc1
    v_mfma_f32_32x32x16_bf16 v[144:159], v[76:79], v[228:231], v[144:159]
    ds_read_b64_tr_b16 v[48:49], v13 offset:49280
    ds_read_b64_tr_b16 v[50:51], v13 offset:50048
    buffer_load_dwordx4 v[24:27], v16, s[12:15], s85 offen offset:3072 sc1
    s_add_u32 s85, s85, 4096
    v_mfma_f32_32x32x16_bf16 v[160:175], v[80:83], v[228:231], v[160:175]
    ds_read_b64_tr_b16 v[52:53], v13 offset:49312
    ds_read_b64_tr_b16 v[54:55], v13 offset:50080
    buffer_load_dwordx4 v12, s[32:35], s89 offen offset:2048 lds
    s_waitcnt vmcnt(11)
    v_add_f32 v2, v2, v3
    v_add_f32 v4, v4, v5
    v_add_f32 v2, v2, v96
    v_add_f32 v2, v2, v4
    ds_write_b32 v126, v2 offset:0
    s_waitcnt lgkmcnt(5)
    v_mfma_f32_32x32x16_bf16 v[176:191], v[84:87], v[228:231], v[176:191]
    ds_read_b64_tr_b16 v[56:57], v13 offset:49344
    ds_read_b64_tr_b16 v[58:59], v13 offset:50112
    v_mfma_f32_32x32x16_bf16 v[192:207], v[88:91], v[228:231], v[192:207]
    ds_read_b64_tr_b16 v[60:61], v13 offset:49376
    ds_read_b64_tr_b16 v[62:63], v13 offset:50144
    v_mfma_f32_32x32x16_bf16 v[208:223], v[92:95], v[228:231], v[208:223]
    ds_read_b64_tr_b16 v[64:65], v13 offset:49408
    ds_read_b64_tr_b16 v[66:67], v13 offset:50176
    buffer_load_dwordx4 a[20:23], v16, s[12:15], s88 offen offset:1024 sc1
    s_waitcnt lgkmcnt(4)
    v_mfma_f32_32x32x16_bf16 v[128:143], v[48:51], v[232:235], v[128:143]
    ds_read_b64_tr_b16 v[68:69], v13 offset:49440
    ds_read_b64_tr_b16 v[70:71], v13 offset:50208
    v_mfma_f32_32x32x16_bf16 v[144:159], v[52:55], v[232:235], v[144:159]
    ds_read_b64_tr_b16 v[72:73], v13 offset:52352
    ds_read_b64_tr_b16 v[74:75], v13 offset:53120
    buffer_load_dwordx4 v[28:31], v16, s[12:15], s85 offen offset:0 sc1
    v_mfma_f32_32x32x16_bf16 v[160:175], v[56:59], v[232:235], v[160:175]
    ds_read_b64_tr_b16 v[76:77], v13 offset:52384
    ds_read_b64_tr_b16 v[78:79], v13 offset:53152
    s_waitcnt lgkmcnt(4)
    v_mfma_f32_32x32x16_bf16 v[176:191], v[60:63], v[232:235], v[176:191]
    ds_read_b64_tr_b16 v[80:81], v13 offset:52416
    ds_read_b64_tr_b16 v[82:83], v13 offset:53184
    v_mfma_f32_32x32x16_bf16 v[192:207], v[64:67], v[232:235], v[192:207]
    ds_read_b64_tr_b16 v[84:85], v13 offset:52448
    ds_read_b64_tr_b16 v[86:87], v13 offset:53216
    buffer_load_dwordx4 a[24:27], v16, s[12:15], s88 offen offset:2048 sc1
    v_mfma_f32_32x32x16_bf16 v[208:223], v[68:71], v[232:235], v[208:223]
    ds_read_b64_tr_b16 v[88:89], v13 offset:52480
    ds_read_b64_tr_b16 v[90:91], v13 offset:53248
    s_waitcnt lgkmcnt(4)
    v_mfma_f32_32x32x16_bf16 v[128:143], v[72:75], v[236:239], v[128:143]
    ds_read_b64_tr_b16 v[92:93], v13 offset:52512
    ds_read_b64_tr_b16 v[94:95], v13 offset:53280
    s_barrier
    v_mfma_f32_32x32x16_bf16 v[144:159], v[76:79], v[236:239], v[144:159]
    ds_read_b64_tr_b16 v[48:49], v14 offset:4256
    ds_read_b64_tr_b16 v[50:51], v14 offset:5024
    buffer_load_dwordx4 v[32:35], v16, s[12:15], s85 offen offset:1024 sc1
    v_mfma_f32_32x32x16_bf16 v[160:175], v[80:83], v[236:239], v[160:175]
    ds_read_b64_tr_b16 v[52:53], v14 offset:4288
    ds_read_b64_tr_b16 v[54:55], v14 offset:5056
    buffer_load_dwordx4 a[28:31], v16, s[12:15], s88 offen offset:3072 sc1
    s_add_u32 s88, s88, 4096
    s_waitcnt lgkmcnt(4)
    v_mfma_f32_32x32x16_bf16 v[176:191], v[84:87], v[236:239], v[176:191]
    ds_read_b64_tr_b16 v[56:57], v14 offset:4320
    ds_read_b64_tr_b16 v[58:59], v14 offset:5088
    v_mfma_f32_32x32x16_bf16 v[192:207], v[88:91], v[236:239], v[192:207]
    ds_read_b64_tr_b16 v[60:61], v14 offset:7328
    ds_read_b64_tr_b16 v[62:63], v14 offset:8096
    v_mfma_f32_32x32x16_bf16 v[208:223], v[92:95], v[236:239], v[208:223]
    ds_read_b64_tr_b16 v[64:65], v14 offset:7360
    ds_read_b64_tr_b16 v[66:67], v14 offset:8128
    s_waitcnt lgkmcnt(4)
    v_mfma_f32_32x32x16_bf16 v[128:143], v[48:51], v[240:243], v[128:143]
    ds_read_b64_tr_b16 v[68:69], v14 offset:7392
    ds_read_b64_tr_b16 v[70:71], v14 offset:8160
    v_mfma_f32_32x32x16_bf16 v[144:159], v[52:55], v[240:243], v[144:159]
    ds_read_b64_tr_b16 v[72:73], v13 offset:0
    ds_read_b64_tr_b16 v[74:75], v13 offset:768
    buffer_load_dwordx4 v[36:39], v16, s[12:15], s85 offen offset:2048 sc1
    buffer_load_dwordx4 a[32:35], v16, s[12:15], s88 offen offset:0 sc1
    v_mfma_f32_32x32x16_bf16 v[160:175], v[56:59], v[240:243], v[160:175]
    ds_read_b64_tr_b16 v[76:77], v13 offset:32
    ds_read_b64_tr_b16 v[78:79], v13 offset:800
    s_waitcnt lgkmcnt(4)
    v_mfma_f32_32x32x16_bf16 v[128:143], v[60:63], v[244:247], v[128:143]
    ds_read_b64_tr_b16 v[80:81], v13 offset:64
    ds_read_b64_tr_b16 v[82:83], v13 offset:832
    v_mfma_f32_32x32x16_bf16 v[144:159], v[64:67], v[244:247], v[144:159]
    ds_read_b64_tr_b16 v[84:85], v13 offset:3072
    ds_read_b64_tr_b16 v[86:87], v13 offset:3840
    buffer_load_dwordx4 v[40:43], v16, s[12:15], s85 offen offset:3072 sc1
    s_add_u32 s85, s85, 4096
    v_mfma_f32_32x32x16_bf16 v[160:175], v[68:71], v[244:247], v[160:175]
    ds_read_b64_tr_b16 v[88:89], v13 offset:3104
    ds_read_b64_tr_b16 v[90:91], v13 offset:3872
    s_waitcnt lgkmcnt(4)
    v_mfma_f32_32x32x16_bf16 v[128:143], v[72:75], v[248:251], v[128:143]
    ds_read_b64_tr_b16 v[92:93], v13 offset:3136
    ds_read_b64_tr_b16 v[94:95], v13 offset:3904
    buffer_load_dwordx4 a[36:39], v16, s[12:15], s88 offen offset:1024 sc1
    s_barrier
    v_mfma_f32_32x32x16_bf16 v[144:159], v[76:79], v[248:251], v[144:159]
    ds_read_b64_tr_b16 v[48:49], v13 offset:12320
    ds_read_b64_tr_b16 v[50:51], v13 offset:13088
    buffer_load_dwordx4 v[44:47], v16, s[12:15], s85 offen offset:0 sc1
    v_mfma_f32_32x32x16_bf16 v[160:175], v[80:83], v[248:251], v[160:175]
    ds_read_b64_tr_b16 v[52:53], v13 offset:12352
    ds_read_b64_tr_b16 v[54:55], v13 offset:13120
    s_waitcnt lgkmcnt(4) vmcnt(19)
    v_mfma_f32_32x32x16_bf16 v[128:143], v[84:87], v[252:255], v[128:143]
    ds_read_b64_tr_b16 v[56:57], v13 offset:12384
    ds_read_b64_tr_b16 v[58:59], v13 offset:13152
    v_mfma_f32_32x32x16_bf16 v[144:159], v[88:91], v[252:255], v[144:159]
    ds_read_b64_tr_b16 v[60:61], v13 offset:15392
    ds_read_b64_tr_b16 v[62:63], v13 offset:16160
    buffer_load_dwordx4 v[224:227], v16, s[12:15], s85 offen offset:1024 sc1
    buffer_load_dwordx4 a[40:43], v16, s[12:15], s88 offen offset:2048 sc1
    v_mfma_f32_32x32x16_bf16 v[160:175], v[92:95], v[252:255], v[160:175]
    ds_read_b64_tr_b16 v[64:65], v13 offset:15424
    ds_read_b64_tr_b16 v[66:67], v13 offset:16192
    s_waitcnt lgkmcnt(4) vmcnt(17)
    v_mfma_f32_32x32x16_bf16 v[128:143], v[48:51], v[20:23], v[128:143]
    ds_read_b64_tr_b16 v[68:69], v13 offset:15456
    ds_read_b64_tr_b16 v[70:71], v13 offset:16224
    v_mfma_f32_32x32x16_bf16 v[144:159], v[52:55], v[20:23], v[144:159]
    ds_read_b64_tr_b16 v[72:73], v13 offset:24640
    ds_read_b64_tr_b16 v[74:75], v13 offset:25408
    buffer_load_dwordx4 v[228:231], v16, s[12:15], s85 offen offset:2048 sc1
    v_mfma_f32_32x32x16_bf16 v[160:175], v[56:59], v[20:23], v[160:175]
    ds_read_b64_tr_b16 v[76:77], v13 offset:24672
    ds_read_b64_tr_b16 v[78:79], v13 offset:25440
    s_waitcnt lgkmcnt(4) vmcnt(14)
    v_mfma_f32_32x32x16_bf16 v[128:143], v[60:63], v[24:27], v[128:143]
    ds_read_b64_tr_b16 v[80:81], v13 offset:24704
    ds_read_b64_tr_b16 v[82:83], v13 offset:25472
    buffer_load_dwordx4 a[44:47], v16, s[12:15], s88 offen offset:3072 sc1
    s_add_u32 s88, s88, 4096
    v_mfma_f32_32x32x16_bf16 v[144:159], v[64:67], v[24:27], v[144:159]
    ds_read_b64_tr_b16 v[84:85], v13 offset:27712
    ds_read_b64_tr_b16 v[86:87], v13 offset:28480
    buffer_load_dwordx4 v[232:235], v16, s[12:15], s85 offen offset:3072 sc1
    v_mfma_f32_32x32x16_bf16 v[160:175], v[68:71], v[24:27], v[160:175]
    ds_read_b64_tr_b16 v[88:89], v13 offset:27744
    ds_read_b64_tr_b16 v[90:91], v13 offset:28512
    s_waitcnt lgkmcnt(4) vmcnt(13)
    v_mfma_f32_32x32x16_bf16 v[128:143], v[72:75], v[28:31], v[128:143]
    ds_read_b64_tr_b16 v[92:93], v13 offset:27776
    ds_read_b64_tr_b16 v[94:95], v13 offset:28544
    s_barrier
    v_mfma_f32_32x32x16_bf16 v[144:159], v[76:79], v[28:31], v[144:159]
    ds_read_b64_tr_b16 v[48:49], v13 offset:36960
    ds_read_b64_tr_b16 v[50:51], v13 offset:37728
    v_mfma_f32_32x32x16_bf16 v[160:175], v[80:83], v[28:31], v[160:175]
    ds_read_b64_tr_b16 v[52:53], v13 offset:36992
    ds_read_b64_tr_b16 v[54:55], v13 offset:37760
    buffer_load_dwordx4 a[48:51], v16, s[12:15], s88 offen offset:0 sc1
    s_waitcnt lgkmcnt(4) vmcnt(12)
    v_mfma_f32_32x32x16_bf16 v[128:143], v[84:87], v[32:35], v[128:143]
    ds_read_b64_tr_b16 v[56:57], v13 offset:37024
    ds_read_b64_tr_b16 v[58:59], v13 offset:37792
    v_mfma_f32_32x32x16_bf16 v[144:159], v[88:91], v[32:35], v[144:159]
    ds_read_b64_tr_b16 v[60:61], v13 offset:40032
    ds_read_b64_tr_b16 v[62:63], v13 offset:40800
    v_mfma_f32_32x32x16_bf16 v[160:175], v[92:95], v[32:35], v[160:175]
    ds_read_b64_tr_b16 v[64:65], v13 offset:40064
    ds_read_b64_tr_b16 v[66:67], v13 offset:40832
    s_waitcnt lgkmcnt(4) vmcnt(10)
    v_mfma_f32_32x32x16_bf16 v[128:143], v[48:51], v[36:39], v[128:143]
    ds_read_b64_tr_b16 v[68:69], v13 offset:40096
    ds_read_b64_tr_b16 v[70:71], v13 offset:40864
    buffer_load_dwordx4 a[52:55], v16, s[12:15], s88 offen offset:1024 sc1
    v_mfma_f32_32x32x16_bf16 v[144:159], v[52:55], v[36:39], v[144:159]
    ds_read_b64_tr_b16 v[72:73], v14 offset:16576
    ds_read_b64_tr_b16 v[74:75], v14 offset:17344
    v_mfma_f32_32x32x16_bf16 v[160:175], v[56:59], v[36:39], v[160:175]
    ds_read_b64_tr_b16 v[76:77], v14 offset:16608
    ds_read_b64_tr_b16 v[78:79], v14 offset:17376
    s_waitcnt lgkmcnt(4) vmcnt(9)
    v_mfma_f32_32x32x16_bf16 v[128:143], v[60:63], v[40:43], v[128:143]
    ds_read_b64_tr_b16 v[80:81], v14 offset:16640
    ds_read_b64_tr_b16 v[82:83], v14 offset:17408
    v_mfma_f32_32x32x16_bf16 v[144:159], v[64:67], v[40:43], v[144:159]
    ds_read_b64_tr_b16 v[84:85], v14 offset:19648
    ds_read_b64_tr_b16 v[86:87], v14 offset:20416
    v_mfma_f32_32x32x16_bf16 v[160:175], v[68:71], v[40:43], v[160:175]
    ds_read_b64_tr_b16 v[88:89], v14 offset:19680
    ds_read_b64_tr_b16 v[90:91], v14 offset:20448
    buffer_load_dwordx4 a[56:59], v16, s[12:15], s88 offen offset:2048 sc1
    s_waitcnt lgkmcnt(4) vmcnt(8)
    v_mfma_f32_32x32x16_bf16 v[128:143], v[72:75], v[44:47], v[128:143]
    ds_read_b64_tr_b16 v[92:93], v14 offset:19712
    ds_read_b64_tr_b16 v[94:95], v14 offset:20480
    s_barrier
    v_mfma_f32_32x32x16_bf16 v[144:159], v[76:79], v[44:47], v[144:159]
    ds_read_b64_tr_b16 v[48:49], v14 offset:28896
    ds_read_b64_tr_b16 v[50:51], v14 offset:29664
    v_mfma_f32_32x32x16_bf16 v[160:175], v[80:83], v[44:47], v[160:175]
    ds_read_b64_tr_b16 v[52:53], v14 offset:28928
    ds_read_b64_tr_b16 v[54:55], v14 offset:29696
    s_waitcnt lgkmcnt(4) vmcnt(7)
    v_mfma_f32_32x32x16_bf16 v[128:143], v[84:87], v[224:227], v[128:143]
    ds_read_b64_tr_b16 v[56:57], v14 offset:28960
    ds_read_b64_tr_b16 v[58:59], v14 offset:29728
    v_mfma_f32_32x32x16_bf16 v[144:159], v[88:91], v[224:227], v[144:159]
    ds_read_b64_tr_b16 v[60:61], v14 offset:31968
    ds_read_b64_tr_b16 v[62:63], v14 offset:32736
    buffer_load_dwordx4 a[60:63], v16, s[12:15], s88 offen offset:3072 sc1
    s_add_u32 s88, s88, 4096
    v_mfma_f32_32x32x16_bf16 v[160:175], v[92:95], v[224:227], v[160:175]
    ds_read_b64_tr_b16 v[64:65], v14 offset:32000
    ds_read_b64_tr_b16 v[66:67], v14 offset:32768
    s_waitcnt lgkmcnt(4) vmcnt(6)
    v_mfma_f32_32x32x16_bf16 v[128:143], v[48:51], v[228:231], v[128:143]
    ds_read_b64_tr_b16 v[68:69], v14 offset:32032
    ds_read_b64_tr_b16 v[70:71], v14 offset:32800
    v_mfma_f32_32x32x16_bf16 v[144:159], v[52:55], v[228:231], v[144:159]
    ds_read_b64_tr_b16 v[72:73], v14 offset:4352
    ds_read_b64_tr_b16 v[74:75], v14 offset:5120
    v_mfma_f32_32x32x16_bf16 v[160:175], v[56:59], v[228:231], v[160:175]
    ds_read_b64_tr_b16 v[76:77], v14 offset:4384
    ds_read_b64_tr_b16 v[78:79], v14 offset:5152
    buffer_load_dwordx4 a[64:67], v16, s[12:15], s88 offen offset:0 sc1
    s_waitcnt lgkmcnt(4) vmcnt(5)
    v_mfma_f32_32x32x16_bf16 v[128:143], v[60:63], v[232:235], v[128:143]
    ds_read_b64_tr_b16 v[80:81], v14 offset:4416
    ds_read_b64_tr_b16 v[82:83], v14 offset:5184
    v_mfma_f32_32x32x16_bf16 v[144:159], v[64:67], v[232:235], v[144:159]
    ds_read_b64_tr_b16 v[84:85], v14 offset:7424
    ds_read_b64_tr_b16 v[86:87], v14 offset:8192
    v_mfma_f32_32x32x16_bf16 v[160:175], v[68:71], v[232:235], v[160:175]
    ds_read_b64_tr_b16 v[88:89], v14 offset:7456
    ds_read_b64_tr_b16 v[90:91], v14 offset:8224
    s_waitcnt lgkmcnt(4)
    v_mfma_f32_32x32x16_bf16 v[176:191], v[72:75], v[240:243], v[176:191]
    ds_read_b64_tr_b16 v[92:93], v14 offset:7488
    ds_read_b64_tr_b16 v[94:95], v14 offset:8256
    v_mfma_f32_32x32x16_bf16 v[192:207], v[76:79], v[240:243], v[192:207]
    ds_read_b64_tr_b16 v[48:49], v13 offset:96
    ds_read_b64_tr_b16 v[50:51], v13 offset:864
    buffer_load_dwordx4 a[68:71], v16, s[12:15], s88 offen offset:1024 sc1
    ds_read_b128 v[96:99], v19 offset:0
    ds_read_b128 v[100:103], v19 offset:32
    ds_read_b128 v[104:107], v19 offset:64
    ds_read_b128 v[108:111], v19 offset:96
    s_waitcnt lgkmcnt(0)
    v_mfma_f32_32x32x16_bf16 v[208:223], v[80:83], v[240:243], v[208:223]
    ds_read_b64_tr_b16 v[52:53], v13 offset:128
    ds_read_b64_tr_b16 v[54:55], v13 offset:896
    v_fmac_f32 v128, v96, v122
    v_fmac_f32 v129, v97, v122
    v_fmac_f32 v130, v98, v122
    v_fmac_f32 v131, v99, v122
    v_mfma_f32_32x32x16_bf16 v[176:191], v[84:87], v[244:247], v[176:191]
    ds_read_b64_tr_b16 v[56:57], v13 offset:160
    ds_read_b64_tr_b16 v[58:59], v13 offset:928
    v_fmac_f32 v132, v100, v122
    v_fmac_f32 v133, v101, v122
    v_fmac_f32 v134, v102, v122
    v_fmac_f32 v135, v103, v122
    v_fmac_f32_e64 v136, v104, v122
    v_mfma_f32_32x32x16_bf16 v[192:207], v[88:91], v[244:247], v[192:207]
    ds_read_b64_tr_b16 v[60:61], v13 offset:3168
    ds_read_b64_tr_b16 v[62:63], v13 offset:3936
    v_fmac_f32 v137, v105, v122
    v_fmac_f32 v138, v106, v122
    v_fmac_f32 v139, v107, v122
    v_fmac_f32 v140, v108, v122
    v_mfma_f32_32x32x16_bf16 v[208:223], v[92:95], v[244:247], v[208:223]
    ds_read_b64_tr_b16 v[64:65], v13 offset:3200
    ds_read_b64_tr_b16 v[66:67], v13 offset:3968
    v_fmac_f32 v141, v109, v122
    v_fmac_f32 v142, v110, v122
    v_fmac_f32 v143, v111, v122
    v_mul_f32 v236, v128, v128
    s_waitcnt lgkmcnt(4)
    v_mfma_f32_32x32x16_bf16 v[176:191], v[48:51], v[248:251], v[176:191]
    ds_read_b64_tr_b16 v[68:69], v13 offset:3232
    ds_read_b64_tr_b16 v[70:71], v13 offset:4000
    buffer_load_dwordx4 a[72:75], v16, s[12:15], s88 offen offset:2048 sc1
    v_mul_f32 v237, v129, v129
    v_mul_f32 v238, v130, v130
    v_mul_f32 v239, v131, v131
    v_mul_f32 v240, v132, v132
    v_mul_f32 v241, v133, v133
    v_mfma_f32_32x32x16_bf16 v[192:207], v[52:55], v[248:251], v[192:207]
    ds_read_b64_tr_b16 v[72:73], v13 offset:12416
    ds_read_b64_tr_b16 v[74:75], v13 offset:13184
    v_mul_f32 v242, v134, v134
    v_mul_f32 v243, v135, v135
    v_fma_f32 v236, v236, v7, v6
    v_fma_f32 v237, v237, v7, v6
    v_mfma_f32_32x32x16_bf16 v[208:223], v[56:59], v[248:251], v[208:223]
    ds_read_b64_tr_b16 v[76:77], v13 offset:12448
    ds_read_b64_tr_b16 v[78:79], v13 offset:13216
    v_fma_f32 v238, v238, v7, v6
    v_fma_f32 v239, v239, v7, v6
    v_fma_f32 v240, v240, v7, v6
    v_fma_f32 v241, v241, v7, v6
    v_fma_f32 v242, v242, v7, v6
    s_waitcnt lgkmcnt(4)
    v_mfma_f32_32x32x16_bf16 v[176:191], v[60:63], v[252:255], v[176:191]
    ds_read_b64_tr_b16 v[80:81], v13 offset:12480
    ds_read_b64_tr_b16 v[82:83], v13 offset:13248
    v_fma_f32 v243, v243, v7, v6
    v_mul_f32 v236, v236, v128
    v_mul_f32 v237, v237, v129
    v_mul_f32 v238, v238, v130
    v_mfma_f32_32x32x16_bf16 v[192:207], v[64:67], v[252:255], v[192:207]
    ds_read_b64_tr_b16 v[84:85], v13 offset:15488
    ds_read_b64_tr_b16 v[86:87], v13 offset:16256
    buffer_load_dwordx4 a[76:79], v16, s[12:15], s88 offen offset:3072 sc1
    s_add_u32 s88, s88, 4096
    v_mul_f32 v239, v239, v131
    v_mul_f32 v240, v240, v132
    v_mul_f32 v241, v241, v133
    v_mul_f32 v242, v242, v134
    v_mfma_f32_32x32x16_bf16 v[208:223], v[68:71], v[252:255], v[208:223]
    ds_read_b64_tr_b16 v[88:89], v13 offset:15520
    ds_read_b64_tr_b16 v[90:91], v13 offset:16288
    v_mul_f32 v243, v243, v135
    v_exp_f32 v236, v236
    v_mul_f32 v128, v128, v136
    v_exp_f32 v237, v237
    v_mul_f32 v129, v129, v137
    s_waitcnt lgkmcnt(4)
    v_mfma_f32_32x32x16_bf16 v[176:191], v[72:75], v[20:23], v[176:191]
    ds_read_b64_tr_b16 v[92:93], v13 offset:15552
    ds_read_b64_tr_b16 v[94:95], v13 offset:16320
    v_exp_f32 v238, v238
    v_mul_f32 v130, v130, v138
    v_exp_f32 v239, v239
    v_mul_f32 v131, v131, v139
    v_mfma_f32_32x32x16_bf16 v[192:207], v[76:79], v[20:23], v[192:207]
    ds_read_b64_tr_b16 v[48:49], v13 offset:24736
    ds_read_b64_tr_b16 v[50:51], v13 offset:25504
    v_exp_f32 v240, v240
    v_mul_f32 v132, v132, v140
    v_exp_f32 v241, v241
    v_mul_f32 v133, v133, v141
    v_exp_f32_e64 v242, v242
    v_mfma_f32_32x32x16_bf16 v[208:223], v[80:83], v[20:23], v[208:223]
    ds_read_b64_tr_b16 v[52:53], v13 offset:24768
    ds_read_b64_tr_b16 v[54:55], v13 offset:25536
    v_mul_f32 v134, v134, v142
    v_exp_f32 v243, v243
    v_mul_f32 v135, v135, v143
    v_fma_f32 v236, v236, v124, v124
    s_waitcnt lgkmcnt(4)
    v_mfma_f32_32x32x16_bf16 v[176:191], v[84:87], v[24:27], v[176:191]
    ds_read_b64_tr_b16 v[56:57], v13 offset:24800
    ds_read_b64_tr_b16 v[58:59], v13 offset:25568
    buffer_load_dwordx4 a[80:83], v16, s[12:15], s88 offen offset:0 sc1
    v_fma_f32 v237, v237, v124, v124
    v_fma_f32 v238, v238, v124, v124
    v_fma_f32 v239, v239, v124, v124
    v_fma_f32 v240, v240, v124, v124
    v_mfma_f32_32x32x16_bf16 v[192:207], v[88:91], v[24:27], v[192:207]
    ds_read_b64_tr_b16 v[60:61], v13 offset:27808
    ds_read_b64_tr_b16 v[62:63], v13 offset:28576
    v_fma_f32 v241, v241, v124, v124
    v_fma_f32 v242, v242, v124, v124
    v_fma_f32 v243, v243, v124, v124
    v_rcp_f32 v236, v236
    v_rcp_f32 v237, v237
    v_mfma_f32_32x32x16_bf16 v[208:223], v[92:95], v[24:27], v[208:223]
    ds_read_b64_tr_b16 v[64:65], v13 offset:27840
    ds_read_b64_tr_b16 v[66:67], v13 offset:28608
    v_rcp_f32 v238, v238
    v_rcp_f32 v239, v239
    v_rcp_f32 v240, v240
    v_rcp_f32 v241, v241
    s_waitcnt lgkmcnt(4)
    v_mfma_f32_32x32x16_bf16 v[176:191], v[48:51], v[28:31], v[176:191]
    ds_read_b64_tr_b16 v[68:69], v13 offset:27872
    ds_read_b64_tr_b16 v[70:71], v13 offset:28640
    v_rcp_f32 v242, v242
    v_rcp_f32 v243, v243
    v_mul_f32 v128, v128, v236
    v_mul_f32 v129, v129, v237
    v_mul_f32 v130, v130, v238
    v_mfma_f32_32x32x16_bf16 v[192:207], v[52:55], v[28:31], v[192:207]
    ds_read_b64_tr_b16 v[72:73], v13 offset:37056
    ds_read_b64_tr_b16 v[74:75], v13 offset:37824
    v_mul_f32 v131, v131, v239
    v_mul_f32 v132, v132, v240
    v_mul_f32 v133, v133, v241
    v_mul_f32 v134, v134, v242
    v_mfma_f32_32x32x16_bf16 v[208:223], v[56:59], v[28:31], v[208:223]
    ds_read_b64_tr_b16 v[76:77], v13 offset:37088
    ds_read_b64_tr_b16 v[78:79], v13 offset:37856
    buffer_load_dwordx4 a[84:87], v16, s[12:15], s88 offen offset:1024 sc1
    v_mul_f32_e64 v135, v135, v243
    v_cvt_pk_bf16_f32 v244, v128, v129
    v_cvt_pk_bf16_f32 v245, v130, v131
    v_cvt_pk_bf16_f32 v246, v132, v133
    s_waitcnt lgkmcnt(4)
    v_mfma_f32_32x32x16_bf16 v[176:191], v[60:63], v[32:35], v[176:191]
    ds_read_b64_tr_b16 v[80:81], v13 offset:37120
    ds_read_b64_tr_b16 v[82:83], v13 offset:37888
    v_cvt_pk_bf16_f32 v247, v134, v135
    buffer_store_dwordx4 v[244:247], v15, s[12:15], s79 offen offset:0 sc1
    ds_read_b128 v[96:99], v19 offset:128
    ds_read_b128 v[100:103], v19 offset:160
    ds_read_b128 v[104:107], v19 offset:192
    v_mfma_f32_32x32x16_bf16 v[192:207], v[64:67], v[32:35], v[192:207]
    ds_read_b64_tr_b16 v[84:85], v13 offset:40128
    ds_read_b64_tr_b16 v[86:87], v13 offset:40896
    ds_read_b128 v[108:111], v19 offset:224
    s_waitcnt lgkmcnt(0)
    v_fmac_f32 v144, v96, v122
    v_fmac_f32 v145, v97, v122
    v_mfma_f32_32x32x16_bf16 v[208:223], v[68:71], v[32:35], v[208:223]
    ds_read_b64_tr_b16 v[88:89], v13 offset:40160
    ds_read_b64_tr_b16 v[90:91], v13 offset:40928
    v_fmac_f32 v146, v98, v122
    v_fmac_f32 v147, v99, v122
    v_fmac_f32 v148, v100, v122
    v_fmac_f32 v149, v101, v122
    v_mfma_f32_32x32x16_bf16 v[176:191], v[72:75], v[36:39], v[176:191]
    ds_read_b64_tr_b16 v[92:93], v13 offset:40192
    ds_read_b64_tr_b16 v[94:95], v13 offset:40960
    buffer_load_dwordx4 a[88:91], v16, s[12:15], s88 offen offset:2048 sc1
    v_fmac_f32 v150, v102, v122
    v_fmac_f32 v151, v103, v122
    v_fmac_f32 v152, v104, v122
    v_fmac_f32 v153, v105, v122
    v_fmac_f32_e64 v154, v106, v122
    v_mfma_f32_32x32x16_bf16 v[192:207], v[76:79], v[36:39], v[192:207]
    ds_read_b64_tr_b16 v[48:49], v14 offset:16672
    ds_read_b64_tr_b16 v[50:51], v14 offset:17440
    v_fmac_f32 v155, v107, v122
    v_fmac_f32 v156, v108, v122
    v_fmac_f32 v157, v109, v122
    v_fmac_f32 v158, v110, v122
    v_mfma_f32_32x32x16_bf16 v[208:223], v[80:83], v[36:39], v[208:223]
    ds_read_b64_tr_b16 v[52:53], v14 offset:16704
    ds_read_b64_tr_b16 v[54:55], v14 offset:17472
    v_fmac_f32 v159, v111, v122
    v_mul_f32 v236, v144, v144
    v_mul_f32 v237, v145, v145
    v_mul_f32 v238, v146, v146
    v_mul_f32 v239, v147, v147
    s_waitcnt lgkmcnt(4)
    v_mfma_f32_32x32x16_bf16 v[176:191], v[84:87], v[40:43], v[176:191]
    ds_read_b64_tr_b16 v[56:57], v14 offset:16736
    ds_read_b64_tr_b16 v[58:59], v14 offset:17504
    v_mul_f32 v240, v148, v148
    v_mul_f32 v241, v149, v149
    v_mul_f32 v242, v150, v150
    v_mul_f32 v243, v151, v151
    v_mfma_f32_32x32x16_bf16 v[192:207], v[88:91], v[40:43], v[192:207]
    ds_read_b64_tr_b16 v[60:61], v14 offset:19744
    ds_read_b64_tr_b16 v[62:63], v14 offset:20512
    v_fma_f32 v236, v236, v7, v6
    v_fma_f32 v237, v237, v7, v6
    v_fma_f32 v238, v238, v7, v6
    v_fma_f32 v239, v239, v7, v6
    v_mfma_f32_32x32x16_bf16 v[208:223], v[92:95], v[40:43], v[208:223]
    ds_read_b64_tr_b16 v[64:65], v14 offset:19776
    ds_read_b64_tr_b16 v[66:67], v14 offset:20544
    buffer_load_dwordx4 a[92:95], v16, s[12:15], s88 offen offset:3072 sc1
    s_add_u32 s88, s88, 4096
    v_fma_f32 v240, v240, v7, v6
    v_fma_f32 v241, v241, v7, v6
    v_fma_f32 v242, v242, v7, v6
    v_fma_f32 v243, v243, v7, v6
    v_mul_f32 v236, v236, v144
    s_waitcnt lgkmcnt(4)
    v_mfma_f32_32x32x16_bf16 v[176:191], v[48:51], v[44:47], v[176:191]
    ds_read_b64_tr_b16 v[68:69], v14 offset:19808
    ds_read_b64_tr_b16 v[70:71], v14 offset:20576
    v_mul_f32 v237, v237, v145
    v_mul_f32 v238, v238, v146
    v_mul_f32 v239, v239, v147
    v_mul_f32 v240, v240, v148
    v_mfma_f32_32x32x16_bf16 v[192:207], v[52:55], v[44:47], v[192:207]
    ds_read_b64_tr_b16 v[72:73], v14 offset:28992
    ds_read_b64_tr_b16 v[74:75], v14 offset:29760
    v_mul_f32 v241, v241, v149
    v_mul_f32 v242, v242, v150
    v_mul_f32 v243, v243, v151
    v_exp_f32 v236, v236
    v_mul_f32_e64 v144, v144, v152
    v_mfma_f32_32x32x16_bf16 v[208:223], v[56:59], v[44:47], v[208:223]
    ds_read_b64_tr_b16 v[76:77], v14 offset:29024
    ds_read_b64_tr_b16 v[78:79], v14 offset:29792
    v_exp_f32 v237, v237
    v_mul_f32 v145, v145, v153
    v_exp_f32 v238, v238
    v_mul_f32 v146, v146, v154
    s_waitcnt lgkmcnt(4)
    v_mfma_f32_32x32x16_bf16 v[176:191], v[60:63], v[224:227], v[176:191]
    ds_read_b64_tr_b16 v[80:81], v14 offset:29056
    ds_read_b64_tr_b16 v[82:83], v14 offset:29824
    v_exp_f32 v239, v239
    v_mul_f32 v147, v147, v155
    v_exp_f32 v240, v240
    v_mul_f32_e64 v148, v148, v156
    v_mfma_f32_32x32x16_bf16 v[192:207], v[64:67], v[224:227], v[192:207]
    ds_read_b64_tr_b16 v[84:85], v14 offset:32064
    ds_read_b64_tr_b16 v[86:87], v14 offset:32832
    v_exp_f32 v241, v241
    v_mul_f32 v149, v149, v157
    v_exp_f32 v242, v242
    v_mul_f32 v150, v150, v158
    v_exp_f32_e64 v243, v243
    v_mfma_f32_32x32x16_bf16 v[208:223], v[68:71], v[224:227], v[208:223]
    ds_read_b64_tr_b16 v[88:89], v14 offset:32096
    ds_read_b64_tr_b16 v[90:91], v14 offset:32864
    v_mul_f32_e64 v151, v151, v159
    v_fma_f32 v236, v236, v124, v124
    v_fma_f32 v237, v237, v124, v124
    v_fma_f32 v238, v238, v124, v124
    s_waitcnt lgkmcnt(4)
    v_mfma_f32_32x32x16_bf16 v[176:191], v[72:75], v[228:231], v[176:191]
    ds_read_b64_tr_b16 v[92:93], v14 offset:32128
    ds_read_b64_tr_b16 v[94:95], v14 offset:32896
    v_fma_f32 v239, v239, v124, v124
    v_fma_f32 v240, v240, v124, v124
    v_fma_f32 v241, v241, v124, v124
    v_fma_f32 v242, v242, v124, v124
    v_fma_f32 v243, v243, v124, v124
    v_mfma_f32_32x32x16_bf16 v[192:207], v[76:79], v[228:231], v[192:207]
    v_rcp_f32 v236, v236
    v_rcp_f32 v237, v237
    v_rcp_f32 v238, v238
    v_rcp_f32 v239, v239
    v_mfma_f32_32x32x16_bf16 v[208:223], v[80:83], v[228:231], v[208:223]
    v_rcp_f32 v240, v240
    v_rcp_f32 v241, v241
    v_rcp_f32 v242, v242
    v_rcp_f32 v243, v243
    s_waitcnt lgkmcnt(0)
    v_mfma_f32_32x32x16_bf16 v[176:191], v[84:87], v[232:235], v[176:191]
    v_mul_f32 v144, v144, v236
    v_mul_f32 v145, v145, v237
    v_mul_f32 v146, v146, v238
    v_mul_f32 v147, v147, v239
    v_mul_f32 v148, v148, v240
    v_mfma_f32_32x32x16_bf16 v[192:207], v[88:91], v[232:235], v[192:207]
    v_mul_f32 v149, v149, v241
    v_mul_f32 v150, v150, v242
    v_mul_f32 v151, v151, v243
    v_cvt_pk_bf16_f32 v244, v144, v145
    v_mfma_f32_32x32x16_bf16 v[208:223], v[92:95], v[232:235], v[208:223]
    v_cvt_pk_bf16_f32 v245, v146, v147
    v_cvt_pk_bf16_f32 v246, v148, v149
    v_cvt_pk_bf16_f32 v247, v150, v151
    buffer_store_dwordx4 v[244:247], v15, s[12:15], s79 offen offset:512 sc1
    ds_read_b128 v[20:23], v19 offset:256
    ds_read_b128 v[24:27], v19 offset:288
    ds_read_b128 v[28:31], v19 offset:320
    ds_read_b128 v[32:35], v19 offset:352
    ds_read_b128 v[224:227], v19 offset:384
    ds_read_b128 v[228:231], v19 offset:416
    ds_read_b128 v[232:235], v19 offset:448
    ds_read_b128 v[236:239], v19 offset:480
    ds_read_b128 v[96:99], v19 offset:512
    ds_read_b128 v[100:103], v19 offset:544
    ds_read_b128 v[104:107], v19 offset:576
    ds_read_b128 v[108:111], v19 offset:608
    s_waitcnt lgkmcnt(8)
    buffer_load_dwordx4 a[96:99], v16, s[12:15], s88 offen offset:0 sc1
    v_pk_fma_f32 v[160:161], v[20:21], v[122:123], v[160:161] op_sel_hi:[1,0,1]
    v_pk_fma_f32 v[162:163], v[22:23], v[122:123], v[162:163] op_sel_hi:[1,0,1]
    v_pk_fma_f32 v[164:165], v[24:25], v[122:123], v[164:165] op_sel_hi:[1,0,1]
    v_pk_fma_f32 v[166:167], v[26:27], v[122:123], v[166:167] op_sel_hi:[1,0,1]
    v_pk_fma_f32 v[168:169], v[28:29], v[122:123], v[168:169] op_sel_hi:[1,0,1]
    v_pk_fma_f32 v[170:171], v[30:31], v[122:123], v[170:171] op_sel_hi:[1,0,1]
    v_pk_fma_f32 v[172:173], v[32:33], v[122:123], v[172:173] op_sel_hi:[1,0,1]
    v_pk_fma_f32 v[174:175], v[34:35], v[122:123], v[174:175] op_sel_hi:[1,0,1]
    v_pk_mul_f32 v[36:37], v[160:161], v[160:161]
    v_pk_mul_f32 v[38:39], v[162:163], v[162:163]
    v_pk_mul_f32 v[40:41], v[164:165], v[164:165]
    v_pk_mul_f32 v[42:43], v[166:167], v[166:167]
    v_pk_fma_f32 v[36:37], v[36:37], v[6:7], v[6:7] op_sel:[0,1,0] op_sel_hi:[1,1,0]
    v_pk_fma_f32 v[38:39], v[38:39], v[6:7], v[6:7] op_sel:[0,1,0] op_sel_hi:[1,1,0]
    v_pk_fma_f32 v[40:41], v[40:41], v[6:7], v[6:7] op_sel:[0,1,0] op_sel_hi:[1,1,0]
    v_pk_fma_f32 v[42:43], v[42:43], v[6:7], v[6:7] op_sel:[0,1,0] op_sel_hi:[1,1,0]
    v_pk_mul_f32 v[36:37], v[36:37], v[160:161]
    v_pk_mul_f32 v[38:39], v[38:39], v[162:163]
    v_pk_mul_f32 v[40:41], v[40:41], v[164:165]
    buffer_load_dwordx4 a[100:103], v16, s[12:15], s88 offen offset:1024 sc1
    v_pk_mul_f32 v[42:43], v[42:43], v[166:167]
    v_exp_f32 v36, v36
    v_exp_f32 v37, v37
    v_exp_f32 v38, v38
    v_exp_f32 v39, v39
    v_exp_f32 v40, v40
    v_exp_f32 v41, v41
    v_exp_f32 v42, v42
    v_exp_f32_e64 v43, v43
    v_pk_mul_f32 v[160:161], v[160:161], v[168:169]
    v_pk_mul_f32 v[162:163], v[162:163], v[170:171]
    buffer_load_dwordx4 a[104:107], v16, s[12:15], s88 offen offset:2048 sc1
    v_pk_mul_f32 v[164:165], v[164:165], v[172:173]
    v_pk_mul_f32 v[166:167], v[166:167], v[174:175]
    v_pk_fma_f32 v[36:37], v[36:37], v[124:125], v[124:125] op_sel_hi:[1,0,0]
    v_pk_fma_f32 v[38:39], v[38:39], v[124:125], v[124:125] op_sel_hi:[1,0,0]
    v_pk_fma_f32 v[40:41], v[40:41], v[124:125], v[124:125] op_sel_hi:[1,0,0]
    v_pk_fma_f32 v[42:43], v[42:43], v[124:125], v[124:125] op_sel_hi:[1,0,0]
    v_rcp_f32 v36, v36
    v_rcp_f32 v37, v37
    v_rcp_f32 v38, v38
    v_rcp_f32 v39, v39
    v_rcp_f32 v40, v40
    v_rcp_f32 v41, v41
    v_rcp_f32 v42, v42
    buffer_load_dwordx4 a[108:111], v16, s[12:15], s88 offen offset:3072 sc1
    s_add_u32 s88, s88, 4096
    v_rcp_f32 v43, v43
    v_pk_mul_f32 v[160:161], v[160:161], v[36:37]
    v_pk_mul_f32 v[162:163], v[162:163], v[38:39]
    v_pk_mul_f32 v[164:165], v[164:165], v[40:41]
    v_pk_mul_f32 v[166:167], v[166:167], v[42:43]
    v_cvt_pk_bf16_f32 v44, v160, v161
    v_cvt_pk_bf16_f32 v45, v162, v163
    v_cvt_pk_bf16_f32 v46, v164, v165
    v_cvt_pk_bf16_f32 v47, v166, v167
    buffer_store_dwordx4 v[44:47], v15, s[12:15], s79 offen offset:1024 sc1
    s_waitcnt lgkmcnt(4)
    v_pk_fma_f32 v[176:177], v[224:225], v[122:123], v[176:177] op_sel_hi:[1,0,1]
    v_pk_fma_f32 v[178:179], v[226:227], v[122:123], v[178:179] op_sel_hi:[1,0,1]
    v_pk_fma_f32 v[180:181], v[228:229], v[122:123], v[180:181] op_sel_hi:[1,0,1]
    v_pk_fma_f32 v[182:183], v[230:231], v[122:123], v[182:183] op_sel_hi:[1,0,1]
    v_pk_fma_f32 v[184:185], v[232:233], v[122:123], v[184:185] op_sel_hi:[1,0,1]
    v_pk_fma_f32 v[186:187], v[234:235], v[122:123], v[186:187] op_sel_hi:[1,0,1]
    v_pk_fma_f32 v[188:189], v[236:237], v[122:123], v[188:189] op_sel_hi:[1,0,1]
    buffer_load_dwordx4 a[112:115], v16, s[12:15], s88 offen offset:0 sc1
    v_pk_fma_f32 v[190:191], v[238:239], v[122:123], v[190:191] op_sel_hi:[1,0,1]
    v_pk_mul_f32 v[240:241], v[176:177], v[176:177]
    ds_read_b128 v[48:51], v19 offset:640
    ds_read_b128 v[52:55], v19 offset:672
    ds_read_b128 v[56:59], v19 offset:704
    ds_read_b128 v[60:63], v19 offset:736
    v_pk_mul_f32 v[242:243], v[178:179], v[178:179]
    v_pk_mul_f32 v[244:245], v[180:181], v[180:181]
    v_pk_mul_f32 v[246:247], v[182:183], v[182:183]
    v_pk_fma_f32 v[240:241], v[240:241], v[6:7], v[6:7] op_sel:[0,1,0] op_sel_hi:[1,1,0]
    v_pk_fma_f32 v[242:243], v[242:243], v[6:7], v[6:7] op_sel:[0,1,0] op_sel_hi:[1,1,0]
    v_pk_fma_f32 v[244:245], v[244:245], v[6:7], v[6:7] op_sel:[0,1,0] op_sel_hi:[1,1,0]
    v_pk_fma_f32 v[246:247], v[246:247], v[6:7], v[6:7] op_sel:[0,1,0] op_sel_hi:[1,1,0]
    v_pk_mul_f32 v[240:241], v[240:241], v[176:177]
    v_pk_mul_f32 v[242:243], v[242:243], v[178:179]
    v_pk_mul_f32 v[244:245], v[244:245], v[180:181]
    v_pk_mul_f32 v[246:247], v[246:247], v[182:183]
    v_exp_f32 v240, v240
    buffer_load_dwordx4 a[116:119], v16, s[12:15], s88 offen offset:1024 sc1
    v_exp_f32 v241, v241
    v_exp_f32 v242, v242
    v_exp_f32 v243, v243
    v_exp_f32 v244, v244
    v_exp_f32 v245, v245
    v_exp_f32 v246, v246
    v_exp_f32_e64 v247, v247
    v_pk_mul_f32 v[176:177], v[176:177], v[184:185]
    v_pk_mul_f32 v[178:179], v[178:179], v[186:187]
    v_pk_mul_f32 v[180:181], v[180:181], v[188:189]
    v_pk_mul_f32 v[182:183], v[182:183], v[190:191]
    v_pk_fma_f32 v[240:241], v[240:241], v[124:125], v[124:125] op_sel_hi:[1,0,0]
    buffer_load_dwordx4 a[120:123], v16, s[12:15], s88 offen offset:2048 sc1
    v_pk_fma_f32 v[242:243], v[242:243], v[124:125], v[124:125] op_sel_hi:[1,0,0]
    v_pk_fma_f32 v[244:245], v[244:245], v[124:125], v[124:125] op_sel_hi:[1,0,0]
    v_pk_fma_f32 v[246:247], v[246:247], v[124:125], v[124:125] op_sel_hi:[1,0,0]
    v_rcp_f32 v240, v240
    v_rcp_f32 v241, v241
    v_rcp_f32 v242, v242
    v_rcp_f32 v243, v243
    v_rcp_f32 v244, v244
    v_rcp_f32 v245, v245
    v_rcp_f32 v246, v246
    v_rcp_f32 v247, v247
    buffer_load_dwordx4 a[124:127], v16, s[12:15], s88 offen offset:3072 sc1
    s_add_u32 s88, s88, 4096
    v_pk_mul_f32 v[176:177], v[176:177], v[240:241]
    v_pk_mul_f32 v[178:179], v[178:179], v[242:243]
    v_pk_mul_f32 v[180:181], v[180:181], v[244:245]
    v_pk_mul_f32 v[182:183], v[182:183], v[246:247]
    v_cvt_pk_bf16_f32 v248, v176, v177
    v_cvt_pk_bf16_f32 v249, v178, v179
    v_cvt_pk_bf16_f32 v250, v180, v181
    v_cvt_pk_bf16_f32 v251, v182, v183
    buffer_store_dwordx4 v[248:251], v15, s[12:15], s79 offen offset:1536 sc1
    s_waitcnt lgkmcnt(4)
    v_pk_fma_f32 v[192:193], v[96:97], v[122:123], v[192:193] op_sel_hi:[1,0,1]
    v_pk_fma_f32 v[194:195], v[98:99], v[122:123], v[194:195] op_sel_hi:[1,0,1]
    v_pk_fma_f32 v[196:197], v[100:101], v[122:123], v[196:197] op_sel_hi:[1,0,1]
    v_pk_fma_f32 v[198:199], v[102:103], v[122:123], v[198:199] op_sel_hi:[1,0,1]
    v_pk_fma_f32 v[200:201], v[104:105], v[122:123], v[200:201] op_sel_hi:[1,0,1]
    v_pk_fma_f32 v[202:203], v[106:107], v[122:123], v[202:203] op_sel_hi:[1,0,1]
    v_pk_fma_f32 v[204:205], v[108:109], v[122:123], v[204:205] op_sel_hi:[1,0,1]
    v_pk_fma_f32 v[206:207], v[110:111], v[122:123], v[206:207] op_sel_hi:[1,0,1]
    v_pk_mul_f32 v[76:77], v[192:193], v[192:193]
    buffer_load_dwordx4 a[128:131], v16, s[12:15], s88 offen offset:0 sc1
    v_pk_mul_f32 v[78:79], v[194:195], v[194:195]
    v_pk_mul_f32 v[80:81], v[196:197], v[196:197]
    v_pk_mul_f32 v[82:83], v[198:199], v[198:199]
    v_pk_fma_f32 v[76:77], v[76:77], v[6:7], v[6:7] op_sel:[0,1,0] op_sel_hi:[1,1,0]
    v_pk_fma_f32 v[78:79], v[78:79], v[6:7], v[6:7] op_sel:[0,1,0] op_sel_hi:[1,1,0]
    v_pk_fma_f32 v[80:81], v[80:81], v[6:7], v[6:7] op_sel:[0,1,0] op_sel_hi:[1,1,0]
    v_pk_fma_f32 v[82:83], v[82:83], v[6:7], v[6:7] op_sel:[0,1,0] op_sel_hi:[1,1,0]
    v_pk_mul_f32 v[76:77], v[76:77], v[192:193]
    v_pk_mul_f32 v[78:79], v[78:79], v[194:195]
    v_pk_mul_f32 v[80:81], v[80:81], v[196:197]
    v_pk_mul_f32 v[82:83], v[82:83], v[198:199]
    v_exp_f32 v76, v76
    v_exp_f32 v77, v77
    v_exp_f32 v78, v78
    v_exp_f32 v79, v79
    buffer_load_dwordx4 a[132:135], v16, s[12:15], s88 offen offset:1024 sc1
    v_exp_f32 v80, v80
    v_exp_f32 v81, v81
    v_exp_f32 v82, v82
    v_exp_f32_e64 v83, v83
    v_pk_mul_f32 v[192:193], v[192:193], v[200:201]
    v_pk_mul_f32 v[194:195], v[194:195], v[202:203]
    v_pk_mul_f32 v[196:197], v[196:197], v[204:205]
    v_pk_mul_f32 v[198:199], v[198:199], v[206:207]
    v_pk_fma_f32 v[76:77], v[76:77], v[124:125], v[124:125] op_sel_hi:[1,0,0]
    v_pk_fma_f32 v[78:79], v[78:79], v[124:125], v[124:125] op_sel_hi:[1,0,0]
    v_pk_fma_f32 v[80:81], v[80:81], v[124:125], v[124:125] op_sel_hi:[1,0,0]
    v_pk_fma_f32 v[82:83], v[82:83], v[124:125], v[124:125] op_sel_hi:[1,0,0]
    v_rcp_f32 v76, v76
    v_rcp_f32 v77, v77
    buffer_load_dwordx4 a[136:139], v16, s[12:15], s88 offen offset:2048 sc1
    v_rcp_f32 v78, v78
    v_rcp_f32 v79, v79
    v_rcp_f32 v80, v80
    v_rcp_f32 v81, v81
    v_rcp_f32 v82, v82
    v_rcp_f32 v83, v83
    v_pk_mul_f32 v[192:193], v[192:193], v[76:77]
    v_pk_mul_f32 v[194:195], v[194:195], v[78:79]
    v_pk_mul_f32 v[196:197], v[196:197], v[80:81]
    v_pk_mul_f32 v[198:199], v[198:199], v[82:83]
    v_cvt_pk_bf16_f32 v88, v192, v193
    v_cvt_pk_bf16_f32 v89, v194, v195
    buffer_load_dwordx4 a[140:143], v16, s[12:15], s88 offen offset:3072 sc1
    s_add_u32 s88, s88, 4096
    v_cvt_pk_bf16_f32 v90, v196, v197
    v_cvt_pk_bf16_f32 v91, v198, v199
    buffer_store_dwordx4 v[88:91], v15, s[12:15], s79 offen offset:2048 sc1
    s_waitcnt lgkmcnt(0)
    v_pk_fma_f32 v[208:209], v[48:49], v[122:123], v[208:209] op_sel_hi:[1,0,1]
    v_pk_fma_f32 v[210:211], v[50:51], v[122:123], v[210:211] op_sel_hi:[1,0,1]
    v_pk_fma_f32 v[212:213], v[52:53], v[122:123], v[212:213] op_sel_hi:[1,0,1]
    v_pk_fma_f32 v[214:215], v[54:55], v[122:123], v[214:215] op_sel_hi:[1,0,1]
    v_pk_fma_f32 v[216:217], v[56:57], v[122:123], v[216:217] op_sel_hi:[1,0,1]
    v_pk_fma_f32 v[218:219], v[58:59], v[122:123], v[218:219] op_sel_hi:[1,0,1]
    v_pk_fma_f32 v[220:221], v[60:61], v[122:123], v[220:221] op_sel_hi:[1,0,1]
    v_pk_fma_f32 v[222:223], v[62:63], v[122:123], v[222:223] op_sel_hi:[1,0,1]
    v_pk_mul_f32 v[64:65], v[208:209], v[208:209]
    v_pk_mul_f32 v[66:67], v[210:211], v[210:211]
    v_pk_mul_f32 v[68:69], v[212:213], v[212:213]
    v_pk_mul_f32 v[70:71], v[214:215], v[214:215]
    v_pk_fma_f32 v[64:65], v[64:65], v[6:7], v[6:7] op_sel:[0,1,0] op_sel_hi:[1,1,0]
    v_pk_fma_f32 v[66:67], v[66:67], v[6:7], v[6:7] op_sel:[0,1,0] op_sel_hi:[1,1,0]
    v_pk_fma_f32 v[68:69], v[68:69], v[6:7], v[6:7] op_sel:[0,1,0] op_sel_hi:[1,1,0]
    v_pk_fma_f32 v[70:71], v[70:71], v[6:7], v[6:7] op_sel:[0,1,0] op_sel_hi:[1,1,0]
    v_pk_mul_f32 v[64:65], v[64:65], v[208:209]
    v_pk_mul_f32 v[66:67], v[66:67], v[210:211]
    v_pk_mul_f32 v[68:69], v[68:69], v[212:213]
    v_pk_mul_f32 v[70:71], v[70:71], v[214:215]
    v_exp_f32 v64, v64
    v_exp_f32 v65, v65
    v_exp_f32 v66, v66
    v_exp_f32 v67, v67
    v_exp_f32 v68, v68
    v_exp_f32 v69, v69
    v_exp_f32 v70, v70
    v_exp_f32_e64 v71, v71
    v_pk_mul_f32 v[208:209], v[208:209], v[216:217]
    v_pk_mul_f32 v[210:211], v[210:211], v[218:219]
    v_pk_mul_f32 v[212:213], v[212:213], v[220:221]
    v_pk_mul_f32 v[214:215], v[214:215], v[222:223]
    v_pk_fma_f32 v[64:65], v[64:65], v[124:125], v[124:125] op_sel_hi:[1,0,0]
    v_pk_fma_f32 v[66:67], v[66:67], v[124:125], v[124:125] op_sel_hi:[1,0,0]
    v_pk_fma_f32 v[68:69], v[68:69], v[124:125], v[124:125] op_sel_hi:[1,0,0]
    v_pk_fma_f32 v[70:71], v[70:71], v[124:125], v[124:125] op_sel_hi:[1,0,0]
    v_rcp_f32 v64, v64
    v_rcp_f32 v65, v65
    v_rcp_f32 v66, v66
    v_rcp_f32 v67, v67
    v_rcp_f32 v68, v68
    v_rcp_f32 v69, v69
    v_rcp_f32 v70, v70
    v_rcp_f32 v71, v71
    v_pk_mul_f32 v[208:209], v[208:209], v[64:65]
    v_pk_mul_f32 v[210:211], v[210:211], v[66:67]
    v_pk_mul_f32 v[212:213], v[212:213], v[68:69]
    v_pk_mul_f32 v[214:215], v[214:215], v[70:71]
    v_cvt_pk_bf16_f32 v92, v208, v209
    v_cvt_pk_bf16_f32 v93, v210, v211
    v_cvt_pk_bf16_f32 v94, v212, v213
    v_cvt_pk_bf16_f32 v95, v214, v215
    buffer_store_dwordx4 v[92:95], v15, s[12:15], s79 offen offset:2560 sc1
    buffer_load_dwordx4 a[144:147], v16, s[12:15], s88 offen offset:0 sc1
    buffer_load_dwordx4 a[148:151], v16, s[12:15], s88 offen offset:1024 sc1
    buffer_load_dwordx4 a[152:155], v16, s[12:15], s88 offen offset:2048 sc1
    buffer_load_dwordx4 a[156:159], v16, s[12:15], s88 offen offset:3072 sc1
    s_add_u32 s88, s88, 4096
    buffer_load_dwordx4 a[160:163], v16, s[12:15], s88 offen offset:0 sc1
    buffer_load_dwordx4 a[164:167], v16, s[12:15], s88 offen offset:1024 sc1
    buffer_load_dwordx4 a[168:171], v16, s[12:15], s88 offen offset:2048 sc1
    buffer_load_dwordx4 a[172:175], v16, s[12:15], s88 offen offset:3072 sc1
    s_add_u32 s88, s88, 4096
    buffer_load_dwordx4 a[176:179], v16, s[12:15], s88 offen offset:0 sc1
    s_add_u32 s49, s3, 0
    s_and_b32 s49, s49, 3
    s_mul_i32 s50, s49, 49152
    v_add_u32 v36, s50, v16
    s_mul_i32 s50, s49, 15360
    s_add_u32 s50, s50, 98528
    v_add_u32 v47, s50, v16
    s_add_u32 s49, s3, 1
    s_and_b32 s49, s49, 3
    s_mul_i32 s50, s49, 49152
    v_add_u32 v37, s50, v16
    s_mul_i32 s50, s49, 15360
    s_add_u32 s50, s50, 98528
    v_add_u32 v44, s50, v16
    s_add_u32 s49, s3, 2
    s_and_b32 s49, s49, 3
    s_mul_i32 s50, s49, 49152
    v_add_u32 v38, s50, v16
    s_mul_i32 s50, s49, 15360
    s_add_u32 s50, s50, 103648
    v_add_u32 v45, s50, v16
    s_add_u32 s49, s3, 3
    s_and_b32 s49, s49, 3
    s_mul_i32 s50, s49, 49152
    v_add_u32 v39, s50, v16
    s_mul_i32 s50, s49, 15360
    s_add_u32 s50, s50, 108768
    v_add_u32 v46, s50, v16
    s_add_u32 s58, s87, 4096
    s_add_u32 s59, s87, 8192
    v_accvgpr_read_b32 v50, a247
    v_accvgpr_read_b32 v51, a248
    s_waitcnt vmcnt(9)
    s_barrier
    s_add_u32 s73, s73, 2048
    s_cmp_lg_u32 s3, 0
    s_cbranch_scc1 Lw0_38
    v_mov_b32 v30, s54
    v_mov_b32 v31, s55
    s_mov_b64 exec, 1
    s_cmp_eq_u32 s98, 1
    s_cbranch_scc1 Lf_39
    buffer_store_dwordx2 v[30:31], off, s[12:15], s73 sc1
    s_branch Lg_40
Lf_39:
    buffer_store_dwordx2 v[30:31], off, s[12:15], s73
Lg_40:
    s_mov_b64 exec, -1
Lw0_38:
    buffer_load_dwordx4 a[180:183], v16, s[12:15], s88 offen offset:1024 sc1
    buffer_load_dwordx4 a[184:187], v16, s[12:15], s88 offen offset:2048 sc1
    buffer_load_dwordx4 a[188:191], v16, s[12:15], s88 offen offset:3072 sc1
    s_add_u32 s88, s88, 4096
    buffer_load_dwordx4 a[192:195], v16, s[12:15], s88 offen offset:0 sc1
    buffer_load_dwordx4 a[196:199], v16, s[12:15], s88 offen offset:1024 sc1
    buffer_load_dwordx4 a[200:203], v16, s[12:15], s88 offen offset:2048 sc1
    buffer_load_dwordx4 a[204:207], v16, s[12:15], s88 offen offset:3072 sc1
    s_add_u32 s88, s88, 4096
    buffer_load_dwordx4 a[208:211], v16, s[12:15], s88 offen offset:0 sc1
    buffer_load_dwordx4 a[212:215], v16, s[12:15], s88 offen offset:1024 sc1
    buffer_load_dwordx4 a[216:219], v16, s[12:15], s88 offen offset:2048 sc1
    buffer_load_dwordx4 a[220:223], v16, s[12:15], s88 offen offset:3072 sc1
    s_add_u32 s88, s88, 4096
    buffer_load_dwordx4 a[224:227], v16, s[12:15], s88 offen offset:0 sc1
    buffer_load_dwordx4 a[228:231], v16, s[12:15], s88 offen offset:1024 sc1
    buffer_load_dwordx4 a[232:235], v16, s[12:15], s88 offen offset:2048 sc1
    buffer_load_dwordx4 a[236:239], v16, s[12:15], s88 offen offset:3072 sc1
    s_add_u32 s88, s88, 4096
    s_add_u32 s52, s97, 4096
    s_mov_b32 s53, 200000
Lp_41:
    buffer_load_dwordx2 v[2:3], v18, s[12:15], s52 offen sc1
    s_waitcnt vmcnt(0)
    v_cmp_ne_u64 vcc, s[54:55], v[2:3]
    s_cbranch_vccz Ld_42
    s_sleep 1
    s_sub_u32 s53, s53, 1
    s_cmp_gt_i32 s53, 0
    s_cbranch_scc1 Lp_41
Ld_42:
    s_waitcnt vmcnt(0)
    buffer_load_dwordx4 v[208:211], v37, s[12:15], s87 offen offset:0 sc1
    buffer_load_dwordx4 v[212:215], v37, s[12:15], s87 offen offset:1024 sc1
    buffer_load_dwordx4 v[216:219], v37, s[12:15], s87 offen offset:2048 sc1
    buffer_load_dwordx4 v[220:223], v37, s[12:15], s87 offen offset:3072 sc1
    buffer_load_dwordx4 v[224:227], v37, s[12:15], s58 offen offset:0 sc1
    buffer_load_dwordx4 v[228:231], v37, s[12:15], s58 offen offset:1024 sc1
    buffer_load_dwordx4 v[232:235], v37, s[12:15], s58 offen offset:2048 sc1
    buffer_load_dwordx4 v[236:239], v37, s[12:15], s58 offen offset:3072 sc1
    v_lshlrev_b32 v84, 16, v112
    v_and_b32 v85, 0xffff0000, v112
    v_lshlrev_b32 v86, 16, v113
    v_and_b32 v87, 0xffff0000, v113
    v_lshlrev_b32 v88, 16, v114
    v_and_b32 v89, 0xffff0000, v114
    v_lshlrev_b32 v90, 16, v115
    v_and_b32 v91, 0xffff0000, v115
    v_lshlrev_b32 v92, 16, v116
    v_and_b32 v93, 0xffff0000, v116
    v_lshlrev_b32 v94, 16, v117
    v_and_b32 v95, 0xffff0000, v117
    v_lshlrev_b32 v96, 16, v118
    v_and_b32 v97, 0xffff0000, v118
    v_lshlrev_b32 v98, 16, v119
    v_and_b32 v99, 0xffff0000, v119
    v_lshlrev_b32 v100, 16, v120
    v_and_b32 v101, 0xffff0000, v120
    v_lshlrev_b32 v102, 16, v121
    v_and_b32 v103, 0xffff0000, v121
    s_waitcnt vmcnt(7)
    v_mfma_f32_16x16x32_bf16 v[148:151], a[0:3], v[208:211], 0
    v_mfma_f32_16x16x32_bf16 v[152:155], a[4:7], v[208:211], 0
    buffer_load_dwordx4 v[240:243], v37, s[12:15], s59 offen offset:0 sc1
    v_mfma_f32_16x16x32_bf16 v[156:159], a[8:11], v[208:211], 0
    v_mfma_f32_16x16x32_bf16 v[160:163], a[12:15], v[208:211], 0
    v_mfma_f32_16x16x32_bf16 v[164:167], a[16:19], v[208:211], 0
    s_waitcnt vmcnt(7)
    v_mfma_f32_16x16x32_bf16 v[148:151], a[20:23], v[212:215], v[148:151]
    v_mfma_f32_16x16x32_bf16 v[152:155], a[24:27], v[212:215], v[152:155]
    buffer_load_dwordx4 v[244:247], v37, s[12:15], s59 offen offset:1024 sc1
    v_mfma_f32_16x16x32_bf16 v[156:159], a[28:31], v[212:215], v[156:159]
    v_mfma_f32_16x16x32_bf16 v[160:163], a[32:35], v[212:215], v[160:163]
    v_mfma_f32_16x16x32_bf16 v[164:167], a[36:39], v[212:215], v[164:167]
    s_waitcnt vmcnt(7)
    v_mfma_f32_16x16x32_bf16 v[148:151], a[40:43], v[216:219], v[148:151]
    v_mfma_f32_16x16x32_bf16 v[152:155], a[44:47], v[216:219], v[152:155]
    buffer_load_dwordx4 v[248:251], v37, s[12:15], s59 offen offset:2048 sc1
    v_mfma_f32_16x16x32_bf16 v[156:159], a[48:51], v[216:219], v[156:159]
    v_mfma_f32_16x16x32_bf16 v[160:163], a[52:55], v[216:219], v[160:163]
    v_mfma_f32_16x16x32_bf16 v[164:167], a[56:59], v[216:219], v[164:167]
    s_waitcnt vmcnt(7)
    v_mfma_f32_16x16x32_bf16 v[148:151], a[60:63], v[220:223], v[148:151]
    v_mfma_f32_16x16x32_bf16 v[152:155], a[64:67], v[220:223], v[152:155]
    buffer_load_dwordx4 v[252:255], v37, s[12:15], s59 offen offset:3072 sc1
    v_mfma_f32_16x16x32_bf16 v[156:159], a[68:71], v[220:223], v[156:159]
    v_mfma_f32_16x16x32_bf16 v[160:163], a[72:75], v[220:223], v[160:163]
    v_mfma_f32_16x16x32_bf16 v[164:167], a[76:79], v[220:223], v[164:167]
    s_waitcnt vmcnt(7)
    v_mfma_f32_16x16x32_bf16 v[148:151], a[80:83], v[224:227], v[148:151]
    v_mfma_f32_16x16x32_bf16 v[152:155], a[84:87], v[224:227], v[152:155]
    buffer_load_dwordx4 v[52:55], v38, s[12:15], s87 offen offset:0 sc1
    v_mfma_f32_16x16x32_bf16 v[156:159], a[88:91], v[224:227], v[156:159]
    v_mfma_f32_16x16x32_bf16 v[160:163], a[92:95], v[224:227], v[160:163]
    v_mfma_f32_16x16x32_bf16 v[164:167], a[96:99], v[224:227], v[164:167]
    s_waitcnt vmcnt(7)
    v_mfma_f32_16x16x32_bf16 v[148:151], a[100:103], v[228:231], v[148:151]
    v_mfma_f32_16x16x32_bf16 v[152:155], a[104:107], v[228:231], v[152:155]
    buffer_load_dwordx4 v[56:59], v38, s[12:15], s87 offen offset:1024 sc1
    v_mfma_f32_16x16x32_bf16 v[156:159], a[108:111], v[228:231], v[156:159]
    v_mfma_f32_16x16x32_bf16 v[160:163], a[112:115], v[228:231], v[160:163]
    v_mfma_f32_16x16x32_bf16 v[164:167], a[116:119], v[228:231], v[164:167]
    s_waitcnt vmcnt(7)
    v_mfma_f32_16x16x32_bf16 v[148:151], a[120:123], v[232:235], v[148:151]
    v_mfma_f32_16x16x32_bf16 v[152:155], a[124:127], v[232:235], v[152:155]
    buffer_load_dwordx4 v[60:63], v38, s[12:15], s87 offen offset:2048 sc1
    v_mfma_f32_16x16x32_bf16 v[156:159], a[128:131], v[232:235], v[156:159]
    v_mfma_f32_16x16x32_bf16 v[160:163], a[132:135], v[232:235], v[160:163]
    v_mfma_f32_16x16x32_bf16 v[164:167], a[136:139], v[232:235], v[164:167]
    s_waitcnt vmcnt(7)
    v_mfma_f32_16x16x32_bf16 v[148:151], a[140:143], v[236:239], v[148:151]
    v_mfma_f32_16x16x32_bf16 v[152:155], a[144:147], v[236:239], v[152:155]
    buffer_load_dwordx4 v[64:67], v38, s[12:15], s87 offen offset:3072 sc1
    v_mfma_f32_16x16x32_bf16 v[156:159], a[148:151], v[236:239], v[156:159]
    v_mfma_f32_16x16x32_bf16 v[160:163], a[152:155], v[236:239], v[160:163]
    v_mfma_f32_16x16x32_bf16 v[164:167], a[156:159], v[236:239], v[164:167]
    s_waitcnt vmcnt(7)
    v_mfma_f32_16x16x32_bf16 v[148:151], a[160:163], v[240:243], v[148:151]
    v_mfma_f32_16x16x32_bf16 v[152:155], a[164:167], v[240:243], v[152:155]
    buffer_load_dwordx4 v[68:71], v38, s[12:15], s58 offen offset:0 sc1
    v_mfma_f32_16x16x32_bf16 v[156:159], a[168:171], v[240:243], v[156:159]
    v_mfma_f32_16x16x32_bf16 v[160:163], a[172:175], v[240:243], v[160:163]
    v_mfma_f32_16x16x32_bf16 v[164:167], a[176:179], v[240:243], v[164:167]
    s_waitcnt vmcnt(7)
    v_mfma_f32_16x16x32_bf16 v[148:151], a[180:183], v[244:247], v[148:151]
    v_mfma_f32_16x16x32_bf16 v[152:155], a[184:187], v[244:247], v[152:155]
    buffer_load_dwordx4 v[72:75], v38, s[12:15], s58 offen offset:1024 sc1
    v_mfma_f32_16x16x32_bf16 v[156:159], a[188:191], v[244:247], v[156:159]
    v_mfma_f32_16x16x32_bf16 v[160:163], a[192:195], v[244:247], v[160:163]
    v_mfma_f32_16x16x32_bf16 v[164:167], a[196:199], v[244:247], v[164:167]
    s_waitcnt vmcnt(7)
    v_mfma_f32_16x16x32_bf16 v[148:151], a[200:203], v[248:251], v[148:151]
    v_mfma_f32_16x16x32_bf16 v[152:155], a[204:207], v[248:251], v[152:155]
    buffer_load_dwordx4 v[76:79], v38, s[12:15], s58 offen offset:2048 sc1
    v_mfma_f32_16x16x32_bf16 v[156:159], a[208:211], v[248:251], v[156:159]
    v_mfma_f32_16x16x32_bf16 v[160:163], a[212:215], v[248:251], v[160:163]
    v_mfma_f32_16x16x32_bf16 v[164:167], a[216:219], v[248:251], v[164:167]
    s_waitcnt vmcnt(7)
    v_mfma_f32_16x16x32_bf16 v[148:151], a[220:223], v[252:255], v[148:151]
    v_mfma_f32_16x16x32_bf16 v[152:155], a[224:227], v[252:255], v[152:155]
    buffer_load_dwordx4 v[80:83], v38, s[12:15], s58 offen offset:3072 sc1
    v_mfma_f32_16x16x32_bf16 v[156:159], a[228:231], v[252:255], v[156:159]
    v_mfma_f32_16x16x32_bf16 v[160:163], a[232:235], v[252:255], v[160:163]
    v_mfma_f32_16x16x32_bf16 v[164:167], a[236:239], v[252:255], v[164:167]
    s_waitcnt vmcnt(7)
    v_mfma_f32_16x16x32_bf16 v[168:171], a[0:3], v[52:55], 0
    v_mfma_f32_16x16x32_bf16 v[172:175], a[4:7], v[52:55], 0
    buffer_load_dwordx4 v[208:211], v38, s[12:15], s59 offen offset:0 sc1
    v_mfma_f32_16x16x32_bf16 v[176:179], a[8:11], v[52:55], 0
    ds_write_b128 v44, v[148:151] offset:0
    v_mfma_f32_16x16x32_bf16 v[180:183], a[12:15], v[52:55], 0
    v_mfma_f32_16x16x32_bf16 v[184:187], a[16:19], v[52:55], 0
    ds_write_b128 v44, v[152:155] offset:1024
    s_waitcnt vmcnt(7)
    v_mfma_f32_16x16x32_bf16 v[168:171], a[20:23], v[56:59], v[168:171]
    v_mfma_f32_16x16x32_bf16 v[172:175], a[24:27], v[56:59], v[172:175]
    buffer_load_dwordx4 v[212:215], v38, s[12:15], s59 offen offset:1024 sc1
    v_mfma_f32_16x16x32_bf16 v[176:179], a[28:31], v[56:59], v[176:179]
    ds_write_b128 v44, v[156:159] offset:2048
    v_mfma_f32_16x16x32_bf16 v[180:183], a[32:35], v[56:59], v[180:183]
    v_mfma_f32_16x16x32_bf16 v[184:187], a[36:39], v[56:59], v[184:187]
    ds_write_b128 v44, v[160:163] offset:3072
    s_waitcnt vmcnt(7)
    v_mfma_f32_16x16x32_bf16 v[168:171], a[40:43], v[60:63], v[168:171]
    v_mfma_f32_16x16x32_bf16 v[172:175], a[44:47], v[60:63], v[172:175]
    buffer_load_dwordx4 v[216:219], v38, s[12:15], s59 offen offset:2048 sc1
    v_mfma_f32_16x16x32_bf16 v[176:179], a[48:51], v[60:63], v[176:179]
    ds_write_b128 v44, v[164:167] offset:4096
    v_mfma_f32_16x16x32_bf16 v[180:183], a[52:55], v[60:63], v[180:183]
    v_mfma_f32_16x16x32_bf16 v[184:187], a[56:59], v[60:63], v[184:187]
    s_waitcnt vmcnt(7)
    v_mfma_f32_16x16x32_bf16 v[168:171], a[60:63], v[64:67], v[168:171]
    v_mfma_f32_16x16x32_bf16 v[172:175], a[64:67], v[64:67], v[172:175]
    buffer_load_dwordx4 v[220:223], v38, s[12:15], s59 offen offset:3072 sc1
    v_mfma_f32_16x16x32_bf16 v[176:179], a[68:71], v[64:67], v[176:179]
    v_mfma_f32_16x16x32_bf16 v[180:183], a[72:75], v[64:67], v[180:183]
    v_mfma_f32_16x16x32_bf16 v[184:187], a[76:79], v[64:67], v[184:187]
    s_waitcnt vmcnt(7)
    v_mfma_f32_16x16x32_bf16 v[168:171], a[80:83], v[68:71], v[168:171]
    v_mfma_f32_16x16x32_bf16 v[172:175], a[84:87], v[68:71], v[172:175]
    buffer_load_dwordx4 v[224:227], v39, s[12:15], s87 offen offset:0 sc1
    v_mfma_f32_16x16x32_bf16 v[176:179], a[88:91], v[68:71], v[176:179]
    v_mfma_f32_16x16x32_bf16 v[180:183], a[92:95], v[68:71], v[180:183]
    v_mfma_f32_16x16x32_bf16 v[184:187], a[96:99], v[68:71], v[184:187]
    s_waitcnt vmcnt(7)
    v_mfma_f32_16x16x32_bf16 v[168:171], a[100:103], v[72:75], v[168:171]
    v_mfma_f32_16x16x32_bf16 v[172:175], a[104:107], v[72:75], v[172:175]
    buffer_load_dwordx4 v[228:231], v39, s[12:15], s87 offen offset:1024 sc1
    v_mfma_f32_16x16x32_bf16 v[176:179], a[108:111], v[72:75], v[176:179]
    v_mfma_f32_16x16x32_bf16 v[180:183], a[112:115], v[72:75], v[180:183]
    v_mfma_f32_16x16x32_bf16 v[184:187], a[116:119], v[72:75], v[184:187]
    s_waitcnt vmcnt(7)
    v_mfma_f32_16x16x32_bf16 v[168:171], a[120:123], v[76:79], v[168:171]
    v_mfma_f32_16x16x32_bf16 v[172:175], a[124:127], v[76:79], v[172:175]
    buffer_load_dwordx4 v[232:235], v39, s[12:15], s87 offen offset:2048 sc1
    v_mfma_f32_16x16x32_bf16 v[176:179], a[128:131], v[76:79], v[176:179]
    v_mfma_f32_16x16x32_bf16 v[180:183], a[132:135], v[76:79], v[180:183]
    v_mfma_f32_16x16x32_bf16 v[184:187], a[136:139], v[76:79], v[184:187]
    s_waitcnt vmcnt(7)
    v_mfma_f32_16x16x32_bf16 v[168:171], a[140:143], v[80:83], v[168:171]
    v_mfma_f32_16x16x32_bf16 v[172:175], a[144:147], v[80:83], v[172:175]
    buffer_load_dwordx4 v[236:239], v39, s[12:15], s87 offen offset:3072 sc1
    v_mfma_f32_16x16x32_bf16 v[176:179], a[148:151], v[80:83], v[176:179]
    v_mfma_f32_16x16x32_bf16 v[180:183], a[152:155], v[80:83], v[180:183]
    v_mfma_f32_16x16x32_bf16 v[184:187], a[156:159], v[80:83], v[184:187]
    s_waitcnt vmcnt(7)
    v_mfma_f32_16x16x32_bf16 v[168:171], a[160:163], v[208:211], v[168:171]
    v_mfma_f32_16x16x32_bf16 v[172:175], a[164:167], v[208:211], v[172:175]
    buffer_load_dwordx4 v[240:243], v39, s[12:15], s58 offen offset:0 sc1
    v_mfma_f32_16x16x32_bf16 v[176:179], a[168:171], v[208:211], v[176:179]
    v_mfma_f32_16x16x32_bf16 v[180:183], a[172:175], v[208:211], v[180:183]
    v_mfma_f32_16x16x32_bf16 v[184:187], a[176:179], v[208:211], v[184:187]
    s_waitcnt vmcnt(7)
    v_mfma_f32_16x16x32_bf16 v[168:171], a[180:183], v[212:215], v[168:171]
    v_mfma_f32_16x16x32_bf16 v[172:175], a[184:187], v[212:215], v[172:175]
    buffer_load_dwordx4 v[244:247], v39, s[12:15], s58 offen offset:1024 sc1
    v_mfma_f32_16x16x32_bf16 v[176:179], a[188:191], v[212:215], v[176:179]
    v_mfma_f32_16x16x32_bf16 v[180:183], a[192:195], v[212:215], v[180:183]
    v_mfma_f32_16x16x32_bf16 v[184:187], a[196:199], v[212:215], v[184:187]
    s_waitcnt vmcnt(7)
    v_mfma_f32_16x16x32_bf16 v[168:171], a[200:203], v[216:219], v[168:171]
    v_mfma_f32_16x16x32_bf16 v[172:175], a[204:207], v[216:219], v[172:175]
    buffer_load_dwordx4 v[248:251], v39, s[12:15], s58 offen offset:2048 sc1
    v_mfma_f32_16x16x32_bf16 v[176:179], a[208:211], v[216:219], v[176:179]
    v_mfma_f32_16x16x32_bf16 v[180:183], a[212:215], v[216:219], v[180:183]
    v_mfma_f32_16x16x32_bf16 v[184:187], a[216:219], v[216:219], v[184:187]
    s_waitcnt vmcnt(7)
    v_mfma_f32_16x16x32_bf16 v[168:171], a[220:223], v[220:223], v[168:171]
    v_mfma_f32_16x16x32_bf16 v[172:175], a[224:227], v[220:223], v[172:175]
    buffer_load_dwordx4 v[252:255], v39, s[12:15], s58 offen offset:3072 sc1
    v_mfma_f32_16x16x32_bf16 v[176:179], a[228:231], v[220:223], v[176:179]
    v_mfma_f32_16x16x32_bf16 v[180:183], a[232:235], v[220:223], v[180:183]
    v_mfma_f32_16x16x32_bf16 v[184:187], a[236:239], v[220:223], v[184:187]
    s_waitcnt vmcnt(7)
    v_mfma_f32_16x16x32_bf16 v[188:191], a[0:3], v[224:227], 0
    v_mfma_f32_16x16x32_bf16 v[192:195], a[4:7], v[224:227], 0
    buffer_load_dwordx4 v[52:55], v39, s[12:15], s59 offen offset:0 sc1
    v_mfma_f32_16x16x32_bf16 v[196:199], a[8:11], v[224:227], 0
    ds_write_b128 v45, v[168:171] offset:0
    v_mfma_f32_16x16x32_bf16 v[200:203], a[12:15], v[224:227], 0
    v_mfma_f32_16x16x32_bf16 v[204:207], a[16:19], v[224:227], 0
    ds_write_b128 v45, v[172:175] offset:1024
    s_waitcnt vmcnt(7)
    v_mfma_f32_16x16x32_bf16 v[188:191], a[20:23], v[228:231], v[188:191]
    v_mfma_f32_16x16x32_bf16 v[192:195], a[24:27], v[228:231], v[192:195]
    buffer_load_dwordx4 v[56:59], v39, s[12:15], s59 offen offset:1024 sc1
    v_mfma_f32_16x16x32_bf16 v[196:199], a[28:31], v[228:231], v[196:199]
    ds_write_b128 v45, v[176:179] offset:2048
    v_mfma_f32_16x16x32_bf16 v[200:203], a[32:35], v[228:231], v[200:203]
    v_mfma_f32_16x16x32_bf16 v[204:207], a[36:39], v[228:231], v[204:207]
    ds_write_b128 v45, v[180:183] offset:3072
    s_waitcnt vmcnt(7)
    v_mfma_f32_16x16x32_bf16 v[188:191], a[40:43], v[232:235], v[188:191]
    v_mfma_f32_16x16x32_bf16 v[192:195], a[44:47], v[232:235], v[192:195]
    buffer_load_dwordx4 v[60:63], v39, s[12:15], s59 offen offset:2048 sc1
    v_mfma_f32_16x16x32_bf16 v[196:199], a[48:51], v[232:235], v[196:199]
    ds_write_b128 v45, v[184:187] offset:4096
    v_mfma_f32_16x16x32_bf16 v[200:203], a[52:55], v[232:235], v[200:203]
    v_mfma_f32_16x16x32_bf16 v[204:207], a[56:59], v[232:235], v[204:207]
    s_waitcnt vmcnt(7)
    v_mfma_f32_16x16x32_bf16 v[188:191], a[60:63], v[236:239], v[188:191]
    v_mfma_f32_16x16x32_bf16 v[192:195], a[64:67], v[236:239], v[192:195]
    buffer_load_dwordx4 v[64:67], v39, s[12:15], s59 offen offset:3072 sc1
    v_mfma_f32_16x16x32_bf16 v[196:199], a[68:71], v[236:239], v[196:199]
    v_mfma_f32_16x16x32_bf16 v[200:203], a[72:75], v[236:239], v[200:203]
    v_mfma_f32_16x16x32_bf16 v[204:207], a[76:79], v[236:239], v[204:207]
    s_waitcnt vmcnt(7)
    v_mfma_f32_16x16x32_bf16 v[188:191], a[80:83], v[240:243], v[188:191]
    v_mfma_f32_16x16x32_bf16 v[192:195], a[84:87], v[240:243], v[192:195]
    buffer_load_dwordx4 v[68:71], v36, s[12:15], s87 offen offset:0 sc1
    v_mfma_f32_16x16x32_bf16 v[196:199], a[88:91], v[240:243], v[196:199]
    v_mfma_f32_16x16x32_bf16 v[200:203], a[92:95], v[240:243], v[200:203]
    v_mfma_f32_16x16x32_bf16 v[204:207], a[96:99], v[240:243], v[204:207]
    s_waitcnt vmcnt(7)
    v_mfma_f32_16x16x32_bf16 v[188:191], a[100:103], v[244:247], v[188:191]
    v_mfma_f32_16x16x32_bf16 v[192:195], a[104:107], v[244:247], v[192:195]
    buffer_load_dwordx4 v[72:75], v36, s[12:15], s87 offen offset:1024 sc1
    v_mfma_f32_16x16x32_bf16 v[196:199], a[108:111], v[244:247], v[196:199]
    v_mfma_f32_16x16x32_bf16 v[200:203], a[112:115], v[244:247], v[200:203]
    v_mfma_f32_16x16x32_bf16 v[204:207], a[116:119], v[244:247], v[204:207]
    s_waitcnt vmcnt(7)
    v_mfma_f32_16x16x32_bf16 v[188:191], a[120:123], v[248:251], v[188:191]
    v_mfma_f32_16x16x32_bf16 v[192:195], a[124:127], v[248:251], v[192:195]
    buffer_load_dwordx4 v[76:79], v36, s[12:15], s87 offen offset:2048 sc1
    v_mfma_f32_16x16x32_bf16 v[196:199], a[128:131], v[248:251], v[196:199]
    v_mfma_f32_16x16x32_bf16 v[200:203], a[132:135], v[248:251], v[200:203]
    v_mfma_f32_16x16x32_bf16 v[204:207], a[136:139], v[248:251], v[204:207]
    s_waitcnt vmcnt(7)
    v_mfma_f32_16x16x32_bf16 v[188:191], a[140:143], v[252:255], v[188:191]
    v_mfma_f32_16x16x32_bf16 v[192:195], a[144:147], v[252:255], v[192:195]
    buffer_load_dwordx4 v[80:83], v36, s[12:15], s87 offen offset:3072 sc1
    v_mfma_f32_16x16x32_bf16 v[196:199], a[148:151], v[252:255], v[196:199]
    v_mfma_f32_16x16x32_bf16 v[200:203], a[152:155], v[252:255], v[200:203]
    v_mfma_f32_16x16x32_bf16 v[204:207], a[156:159], v[252:255], v[204:207]
    s_waitcnt vmcnt(7)
    v_mfma_f32_16x16x32_bf16 v[188:191], a[160:163], v[52:55], v[188:191]
    v_mfma_f32_16x16x32_bf16 v[192:195], a[164:167], v[52:55], v[192:195]
    buffer_load_dwordx4 v[208:211], v36, s[12:15], s58 offen offset:0 sc1
    v_mfma_f32_16x16x32_bf16 v[196:199], a[168:171], v[52:55], v[196:199]
    v_mfma_f32_16x16x32_bf16 v[200:203], a[172:175], v[52:55], v[200:203]
    v_mfma_f32_16x16x32_bf16 v[204:207], a[176:179], v[52:55], v[204:207]
    s_waitcnt vmcnt(7)
    v_mfma_f32_16x16x32_bf16 v[188:191], a[180:183], v[56:59], v[188:191]
    v_mfma_f32_16x16x32_bf16 v[192:195], a[184:187], v[56:59], v[192:195]
    buffer_load_dwordx4 v[212:215], v36, s[12:15], s58 offen offset:1024 sc1
    v_mfma_f32_16x16x32_bf16 v[196:199], a[188:191], v[56:59], v[196:199]
    v_mfma_f32_16x16x32_bf16 v[200:203], a[192:195], v[56:59], v[200:203]
    v_mfma_f32_16x16x32_bf16 v[204:207], a[196:199], v[56:59], v[204:207]
    s_waitcnt vmcnt(7)
    v_mfma_f32_16x16x32_bf16 v[188:191], a[200:203], v[60:63], v[188:191]
    v_mfma_f32_16x16x32_bf16 v[192:195], a[204:207], v[60:63], v[192:195]
    buffer_load_dwordx4 v[216:219], v36, s[12:15], s58 offen offset:2048 sc1
    v_mfma_f32_16x16x32_bf16 v[196:199], a[208:211], v[60:63], v[196:199]
    v_mfma_f32_16x16x32_bf16 v[200:203], a[212:215], v[60:63], v[200:203]
    v_mfma_f32_16x16x32_bf16 v[204:207], a[216:219], v[60:63], v[204:207]
    s_waitcnt vmcnt(7)
    v_mfma_f32_16x16x32_bf16 v[188:191], a[220:223], v[64:67], v[188:191]
    v_mfma_f32_16x16x32_bf16 v[192:195], a[224:227], v[64:67], v[192:195]
    buffer_load_dwordx4 v[220:223], v36, s[12:15], s58 offen offset:3072 sc1
    v_mfma_f32_16x16x32_bf16 v[196:199], a[228:231], v[64:67], v[196:199]
    v_mfma_f32_16x16x32_bf16 v[200:203], a[232:235], v[64:67], v[200:203]
    v_mfma_f32_16x16x32_bf16 v[204:207], a[236:239], v[64:67], v[204:207]
    s_waitcnt vmcnt(7)
    v_mfma_f32_16x16x32_bf16 v[128:131], a[0:3], v[68:71], v[84:87]
    v_mfma_f32_16x16x32_bf16 v[132:135], a[4:7], v[68:71], v[88:91]
    buffer_load_dwordx4 v[224:227], v36, s[12:15], s59 offen offset:0 sc1
    v_mfma_f32_16x16x32_bf16 v[136:139], a[8:11], v[68:71], v[92:95]
    ds_write_b128 v46, v[188:191] offset:0
    v_mfma_f32_16x16x32_bf16 v[140:143], a[12:15], v[68:71], v[96:99]
    v_mfma_f32_16x16x32_bf16 v[144:147], a[16:19], v[68:71], v[100:103]
    ds_write_b128 v46, v[192:195] offset:1024
    s_waitcnt vmcnt(7)
    v_mfma_f32_16x16x32_bf16 v[128:131], a[20:23], v[72:75], v[128:131]
    v_mfma_f32_16x16x32_bf16 v[132:135], a[24:27], v[72:75], v[132:135]
    buffer_load_dwordx4 v[228:231], v36, s[12:15], s59 offen offset:1024 sc1
    v_mfma_f32_16x16x32_bf16 v[136:139], a[28:31], v[72:75], v[136:139]
    ds_write_b128 v46, v[196:199] offset:2048
    v_mfma_f32_16x16x32_bf16 v[140:143], a[32:35], v[72:75], v[140:143]
    v_mfma_f32_16x16x32_bf16 v[144:147], a[36:39], v[72:75], v[144:147]
    ds_write_b128 v46, v[200:203] offset:3072
    s_waitcnt vmcnt(7)
    v_mfma_f32_16x16x32_bf16 v[128:131], a[40:43], v[76:79], v[128:131]
    v_mfma_f32_16x16x32_bf16 v[132:135], a[44:47], v[76:79], v[132:135]
    buffer_load_dwordx4 v[232:235], v36, s[12:15], s59 offen offset:2048 sc1
    v_mfma_f32_16x16x32_bf16 v[136:139], a[48:51], v[76:79], v[136:139]
    ds_write_b128 v46, v[204:207] offset:4096
    v_mfma_f32_16x16x32_bf16 v[140:143], a[52:55], v[76:79], v[140:143]
    v_mfma_f32_16x16x32_bf16 v[144:147], a[56:59], v[76:79], v[144:147]
    s_waitcnt vmcnt(7)
    v_mfma_f32_16x16x32_bf16 v[128:131], a[60:63], v[80:83], v[128:131]
    v_mfma_f32_16x16x32_bf16 v[132:135], a[64:67], v[80:83], v[132:135]
    buffer_load_dwordx4 v[236:239], v36, s[12:15], s59 offen offset:3072 sc1
    v_mfma_f32_16x16x32_bf16 v[136:139], a[68:71], v[80:83], v[136:139]
    v_mfma_f32_16x16x32_bf16 v[140:143], a[72:75], v[80:83], v[140:143]
    v_mfma_f32_16x16x32_bf16 v[144:147], a[76:79], v[80:83], v[144:147]
    s_waitcnt vmcnt(7)
    v_mfma_f32_16x16x32_bf16 v[128:131], a[80:83], v[208:211], v[128:131]
    v_mfma_f32_16x16x32_bf16 v[132:135], a[84:87], v[208:211], v[132:135]
    v_mfma_f32_16x16x32_bf16 v[136:139], a[88:91], v[208:211], v[136:139]
    v_mfma_f32_16x16x32_bf16 v[140:143], a[92:95], v[208:211], v[140:143]
    v_mfma_f32_16x16x32_bf16 v[144:147], a[96:99], v[208:211], v[144:147]
    s_waitcnt vmcnt(6)
    v_mfma_f32_16x16x32_bf16 v[128:131], a[100:103], v[212:215], v[128:131]
    v_mfma_f32_16x16x32_bf16 v[132:135], a[104:107], v[212:215], v[132:135]
    v_mfma_f32_16x16x32_bf16 v[136:139], a[108:111], v[212:215], v[136:139]
    v_mfma_f32_16x16x32_bf16 v[140:143], a[112:115], v[212:215], v[140:143]
    v_mfma_f32_16x16x32_bf16 v[144:147], a[116:119], v[212:215], v[144:147]
    s_waitcnt vmcnt(5)
    v_mfma_f32_16x16x32_bf16 v[128:131], a[120:123], v[216:219], v[128:131]
    v_mfma_f32_16x16x32_bf16 v[132:135], a[124:127], v[216:219], v[132:135]
    v_mfma_f32_16x16x32_bf16 v[136:139], a[128:131], v[216:219], v[136:139]
    v_mfma_f32_16x16x32_bf16 v[140:143], a[132:135], v[216:219], v[140:143]
    v_mfma_f32_16x16x32_bf16 v[144:147], a[136:139], v[216:219], v[144:147]
    s_waitcnt vmcnt(4) lgkmcnt(0)
    s_barrier
    v_mfma_f32_16x16x32_bf16 v[128:131], a[140:143], v[220:223], v[128:131]
    ds_read_b128 v[148:151], v47 offset:0
    v_mfma_f32_16x16x32_bf16 v[132:135], a[144:147], v[220:223], v[132:135]
    ds_read_b128 v[152:155], v47 offset:1024
    v_mfma_f32_16x16x32_bf16 v[136:139], a[148:151], v[220:223], v[136:139]
    ds_read_b128 v[156:159], v47 offset:2048
    v_mfma_f32_16x16x32_bf16 v[140:143], a[152:155], v[220:223], v[140:143]
    ds_read_b128 v[160:163], v47 offset:3072
    v_mfma_f32_16x16x32_bf16 v[144:147], a[156:159], v[220:223], v[144:147]
    ds_read_b128 v[164:167], v47 offset:4096
    s_waitcnt vmcnt(3)
    v_mfma_f32_16x16x32_bf16 v[128:131], a[160:163], v[224:227], v[128:131]
    ds_read_b128 v[168:171], v47 offset:5120
    v_mfma_f32_16x16x32_bf16 v[132:135], a[164:167], v[224:227], v[132:135]
    ds_read_b128 v[172:175], v47 offset:6144
    v_mfma_f32_16x16x32_bf16 v[136:139], a[168:171], v[224:227], v[136:139]
    ds_read_b128 v[176:179], v47 offset:7168
    v_mfma_f32_16x16x32_bf16 v[140:143], a[172:175], v[224:227], v[140:143]
    ds_read_b128 v[180:183], v47 offset:8192
    v_mfma_f32_16x16x32_bf16 v[144:147], a[176:179], v[224:227], v[144:147]
    ds_read_b128 v[184:187], v47 offset:9216
    s_waitcnt vmcnt(2)
    v_mfma_f32_16x16x32_bf16 v[128:131], a[180:183], v[228:231], v[128:131]
    ds_read_b128 v[188:191], v47 offset:10240
    v_mfma_f32_16x16x32_bf16 v[132:135], a[184:187], v[228:231], v[132:135]
    ds_read_b128 v[192:195], v47 offset:11264
    v_mfma_f32_16x16x32_bf16 v[136:139], a[188:191], v[228:231], v[136:139]
    ds_read_b128 v[196:199], v47 offset:12288
    v_mfma_f32_16x16x32_bf16 v[140:143], a[192:195], v[228:231], v[140:143]
    ds_read_b128 v[200:203], v47 offset:13312
    v_mfma_f32_16x16x32_bf16 v[144:147], a[196:199], v[228:231], v[144:147]
    ds_read_b128 v[204:207], v47 offset:14336
    s_waitcnt vmcnt(1)
    v_mfma_f32_16x16x32_bf16 v[128:131], a[200:203], v[232:235], v[128:131]
    v_mfma_f32_16x16x32_bf16 v[132:135], a[204:207], v[232:235], v[132:135]
    v_mfma_f32_16x16x32_bf16 v[136:139], a[208:211], v[232:235], v[136:139]
    v_mfma_f32_16x16x32_bf16 v[140:143], a[212:215], v[232:235], v[140:143]
    v_mfma_f32_16x16x32_bf16 v[144:147], a[216:219], v[232:235], v[144:147]
    s_waitcnt vmcnt(0)
    v_mfma_f32_16x16x32_bf16 v[128:131], a[220:223], v[236:239], v[128:131]
    v_mfma_f32_16x16x32_bf16 v[132:135], a[224:227], v[236:239], v[132:135]
    v_mfma_f32_16x16x32_bf16 v[136:139], a[228:231], v[236:239], v[136:139]
    v_mfma_f32_16x16x32_bf16 v[140:143], a[232:235], v[236:239], v[140:143]
    v_mfma_f32_16x16x32_bf16 v[144:147], a[236:239], v[236:239], v[144:147]
    s_waitcnt lgkmcnt(10)
    s_nop 2
    v_pk_add_f32 v[128:129], v[128:129], v[148:149]
    v_pk_add_f32 v[130:131], v[130:131], v[150:151]
    v_pk_add_f32 v[132:133], v[132:133], v[152:153]
    v_pk_add_f32 v[134:135], v[134:135], v[154:155]
    v_pk_add_f32 v[136:137], v[136:137], v[156:157]
    v_pk_add_f32 v[138:139], v[138:139], v[158:159]
    v_pk_add_f32 v[140:141], v[140:141], v[160:161]
    v_pk_add_f32 v[142:143], v[142:143], v[162:163]
    v_pk_add_f32 v[144:145], v[144:145], v[164:165]
    v_pk_add_f32 v[146:147], v[146:147], v[166:167]
    s_waitcnt lgkmcnt(5)
    v_pk_add_f32 v[128:129], v[128:129], v[168:169]
    v_pk_add_f32 v[130:131], v[130:131], v[170:171]
    v_pk_add_f32 v[132:133], v[132:133], v[172:173]
    v_pk_add_f32 v[134:135], v[134:135], v[174:175]
    v_pk_add_f32 v[136:137], v[136:137], v[176:177]
    v_pk_add_f32 v[138:139], v[138:139], v[178:179]
    v_pk_add_f32 v[140:141], v[140:141], v[180:181]
    v_pk_add_f32 v[142:143], v[142:143], v[182:183]
    v_pk_add_f32 v[144:145], v[144:145], v[184:185]
    v_pk_add_f32 v[146:147], v[146:147], v[186:187]
    s_waitcnt lgkmcnt(0)
    v_pk_add_f32 v[128:129], v[128:129], v[188:189]
    v_pk_add_f32 v[130:131], v[130:131], v[190:191]
    v_pk_add_f32 v[132:133], v[132:133], v[192:193]
    v_pk_add_f32 v[134:135], v[134:135], v[194:195]
    v_pk_add_f32 v[136:137], v[136:137], v[196:197]
    v_pk_add_f32 v[138:139], v[138:139], v[198:199]
    v_pk_add_f32 v[140:141], v[140:141], v[200:201]
    v_pk_add_f32 v[142:143], v[142:143], v[202:203]
    v_pk_add_f32 v[144:145], v[144:145], v[204:205]
    v_pk_add_f32 v[146:147], v[146:147], v[206:207]
    v_cvt_pk_bf16_f32 v84, v128, v129
    v_cvt_pk_bf16_f32 v85, v130, v131
    v_cvt_pk_bf16_f32 v86, v132, v133
    v_cvt_pk_bf16_f32 v87, v134, v135
    v_cvt_pk_bf16_f32 v88, v136, v137
    v_cvt_pk_bf16_f32 v89, v138, v139
    v_cvt_pk_bf16_f32 v90, v140, v141
    v_cvt_pk_bf16_f32 v91, v142, v143
    v_cvt_pk_bf16_f32 v92, v144, v145
    v_cvt_pk_bf16_f32 v93, v146, v147
    buffer_store_dwordx2 v[92:93], v51, s[24:27], s78 offen offset:128
    v_permlane16_swap_b32 v84, v86
    v_permlane16_swap_b32 v85, v87
    buffer_store_dwordx4 v[84:87], v50, s[24:27], s78 offen offset:0
    v_permlane16_swap_b32 v88, v90
    v_permlane16_swap_b32 v89, v91
    buffer_store_dwordx4 v[88:91], v50, s[24:27], s78 offen offset:64
L_end:
    s_endpgm
Ls_2:
    s_mov_b32 s53, 200000
Lq_4:
    s_sleep 8
    buffer_load_dwordx2 v[216:217], off, s[32:35], 0 sc1
    s_waitcnt vmcnt(0)
    v_cmp_eq_u32 vcc, 0, v217
    s_cbranch_vccz Lb_3
    s_sub_u32 s53, s53, 1
    s_cmp_gt_i32 s53, 0
    s_cbranch_scc1 Lq_4
    s_branch Lb_3
Ls_11:
    s_mov_b32 s53, 200000
Lq_13:
    s_sleep 8
    buffer_load_dwordx2 v[30:31], v7, s[12:15], s94 offen sc1
    s_waitcnt vmcnt(0)
    v_cmp_ne_u64 vcc, s[54:55], v[30:31]
    s_cbranch_vccz Lb_12
    s_sub_u32 s53, s53, 1
    s_cmp_gt_i32 s53, 0
    s_cbranch_scc1 Lq_13
    s_branch Lb_12
Ls_14:
    s_mov_b32 s53, 200000
Lq_16:
    s_sleep 8
    buffer_load_dword v34, v7, s[12:15], s51 offen sc1
    s_waitcnt vmcnt(0)
    v_and_b32 v2, -16, v34
    v_cmp_ne_u32 vcc, s49, v2
    s_cbranch_vccz Lb_15
    s_sub_u32 s53, s53, 1
    s_cmp_gt_i32 s53, 0
    s_cbranch_scc1 Lq_16
    s_branch Lb_15
Ls_18:
    s_mov_b32 s53, 200000
Lq_20:
    s_sleep 8
    buffer_load_dwordx2 v[236:237], v238, s[12:15], s52 offen sc1
    s_waitcnt vmcnt(0)
    v_cmp_ne_u64 vcc, s[54:55], v[236:237]
    s_cbranch_vccz Lb_19
    s_sub_u32 s53, s53, 1
    s_cmp_gt_i32 s53, 0
    s_cbranch_scc1 Lq_20
    s_branch Lb_19
Ls_34:
    s_mov_b32 s53, 200000
Lq_36:
    s_sleep 8
    buffer_load_dwordx4 v[2:5], v16, s[12:15], 0 offen offset:2048 sc1
    s_waitcnt vmcnt(0)
    v_cmp_ne_u32 vcc, s54, v2
    v_cmp_ne_u32 s[66:67], s54, v3
    s_nop 0
    s_or_b64 vcc, vcc, s[66:67]
    v_cmp_ne_u32 s[66:67], s54, v4
    s_nop 0
    s_or_b64 vcc, vcc, s[66:67]
    v_cmp_ne_u32 s[66:67], s54, v5
    s_nop 0
    s_or_b64 vcc, vcc, s[66:67]
    s_cbranch_vccz Lb_35
    s_sub_u32 s53, s53, 1
    s_cmp_gt_i32 s53, 0
    s_cbranch_scc1 Lq_36
    s_branch Lb_35
L_fin:
    s_endpgm
.section .rodata,"a"
.p2align 6
.amdhsa_kernel sequential_preLN__linear_kernel_hedgehog__geglu_ffn__prompt_kernel
  .amdhsa_next_free_vgpr 512
  .amdhsa_next_free_sgpr 102
  .amdhsa_accum_offset 256
  .amdhsa_group_segment_fixed_size 0
  .amdhsa_kernarg_size 88
  .amdhsa_user_sgpr_count 2
  .amdhsa_user_sgpr_kernarg_segment_ptr 1
  .amdhsa_system_sgpr_workgroup_id_x 1
  .amdhsa_float_denorm_mode_32 3
.end_amdhsa_kernel
```
